```python
import torch

def _softmax(x, axis=-1):
    return torch.softmax(x, dim=axis)
def _gelu(x):
    return torch.nn.functional.gelu(x, approximate="tanh")
def _silu(x):
    return torch.nn.functional.silu(x)
def _sigmoid(x):
    return torch.sigmoid(x)
def _layernorm(x, axis=-1, eps=1e-5):
    m = x.mean(dim=axis, keepdim=True)
    v = x.var(dim=axis, keepdim=True, unbiased=False)
    return (x - m) / torch.sqrt(v + eps)
def _scatter_add(tgt, idx, src, axis=0):
    return tgt.clone().index_add_(axis, idx, src)
def _segment_sum(src, seg, n):
    out = torch.zeros((n,) + src.shape[1:], dtype=src.dtype)
    return out.index_add_(0, seg, src)
def _pad(x, pw):
    flat = tuple(v for pair in reversed(pw) for v in pair)
    return torch.nn.functional.pad(x, flat)

kernel_name = 'sequential_preLN__mha_block_cached__dense_activation_silu__decode'

def setup_inputs():

    _w = (lambda a: (lambda t: t.to(torch.bfloat16) if t.is_floating_point() else t)(torch.as_tensor(a)))
    def _A_setup():
        B, Sq, D = 1, 1, 512
        H, Sk, Dh = 32, 16384, 128
        return {
            "x": _w((lambda *s: torch.randn(*s, dtype=torch.bfloat16) * 0.1)(B, Sq, D)),
            "k_cache": _w((lambda *s: torch.randn(*s, dtype=torch.bfloat16) * 1.6)(B, H, Sk, Dh)),
            "v_cache": _w((lambda *s: torch.randn(*s, dtype=torch.bfloat16) * 1.6)(B, H, Sk, Dh)),
            "wq": _w((lambda *s: torch.randn(*s, dtype=torch.bfloat16) * 1.6)(D, H * Dh) * (D ** -0.5)),
            "wo": _w((lambda *s: torch.randn(*s, dtype=torch.bfloat16) * 1.6)(H * Dh, D) * ((H * Dh) ** -0.5)),
        }
    _A_in = _A_setup()

    def _B_setup():
        B, S, D, F = 1, 1, 512, 1792
        return {
            "x": _w((lambda *s: torch.randn(*s, dtype=torch.bfloat16) * 0.1)(B, S, D)),
            "w1": _w((lambda *s: torch.randn(*s, dtype=torch.bfloat16) * 3.2)(D, F) * (D ** -0.5)),
            "w2": _w((lambda *s: torch.randn(*s, dtype=torch.bfloat16) * 3.2)(F, D) * (F ** -0.5)),
        }
    _B_in = _B_setup()

    return {
        "A_x": _A_in["x"],
        "A_k_cache": _A_in["k_cache"],
        "A_v_cache": _A_in["v_cache"],
        "A_wq": _A_in["wq"],
        "A_wo": _A_in["wo"],
        "B_x": _B_in["x"],
        "B_w1": _B_in["w1"],
        "B_w2": _B_in["w2"],
    }

def reference(A_x, A_k_cache, A_v_cache, A_wq, A_wo, B_x, B_w1, B_w2):
    def _A_ref(x, k_cache, v_cache, wq, wo):
        B, Sq, D = x.shape
        H, Dh = 32, 128
        q = (lambda x, *d: x.permute(*d))((x @ wq).reshape(B, Sq, H, Dh), 0, 2, 1, 3)
        scores = torch.einsum("bhqd,bhkd->bhqk", q, k_cache) * (Dh ** -0.5)
        p = _softmax(scores, axis=-1)
        o = torch.einsum("bhqk,bhkd->bhqd", p, v_cache)
        return (lambda x, *d: x.permute(*d))(o, 0, 2, 1, 3).reshape(B, Sq, H * Dh) @ wo

    def _B_ref(x, w1, w2):
        h = torch.einsum("bsd,df->bsf", x, w1)
        h = _silu(h)
        out = torch.einsum("bsf,fd->bsd", h, w2)
        return out

    x = A_x
    h = x + _A_ref(_layernorm(x, axis=-1), A_k_cache, A_v_cache, A_wq, A_wo)
    h2 = h + _B_ref(_layernorm(h, axis=-1), B_w1, B_w2)
    return h2
```

```asm
; @launch grid=(256,1,1) block=(576,1,1) lds=145920
.amdgcn_target "amdgcn-amd-amdhsa--gfx950"
.text
.globl sequential_preLN__mha_block_cached__dense_activation_silu__decode_kernel
.p2align 8
.type sequential_preLN__mha_block_cached__dense_activation_silu__decode_kernel,@function
sequential_preLN__mha_block_cached__dense_activation_silu__decode_kernel:
    s_cmp_ge_u32 s2, 256
    s_cbranch_scc1 L_end
    s_load_dwordx16 s[4:19], s[0:1], 0
    s_load_dwordx2 s[24:25], s[0:1], 80
    v_lshrrev_b32 v2, 6, v0
    v_and_b32 v1, 63, v0
    v_readfirstlane_b32 s3, v2
    s_lshr_b32 s26, s2, 3
    s_and_b32 s27, s2, 7
    s_cmp_eq_u32 s27, 0
    s_cselect_b32 s60, 1, 0
    s_cmp_ge_u32 s26, 28
    s_cselect_b32 s61, 8, 1
    s_cmp_eq_u32 s61, s27
    s_cselect_b32 s60, 2, s60
    s_mov_b32 s62, 4194304
    s_movk_i32 s63, 0xff
    s_cmp_eq_u32 s3, 8
    s_cbranch_scc1 L_service
    v_lshlrev_b32 v2, 12, v2
    v_lshl_add_u32 v2, v1, 4, v2
    v_xor_b32 v5, 0x400, v2
    s_lshl_b32 s53, s27, 2
    s_lshr_b32 s53, 0x65421073, s53
    s_and_b32 s52, s53, 1
    s_bfe_u32 s50, s53, 0x10001
    s_bfe_u32 s53, s53, 0x10002
    s_lshl_b32 s53, s53, 21
    s_lshl_b32 s52, s52, 11
    s_add_u32 s53, s53, s52
    s_lshl_b32 s50, s50, 15
    s_add_u32 s53, s53, s50
    s_and_b32 s93, s27, 1
    s_lshl_b32 s93, s93, 21
    s_bfe_u32 s50, s27, 0x10001
    s_lshl_b32 s50, s50, 20
    s_add_u32 s93, s93, s50
    s_lshr_b32 s50, s27, 2
    s_lshl_b32 s50, s50, 19
    s_add_u32 s93, s93, s50
    s_lshl_b32 s49, s26, 22
    s_mov_b32 s48, s93
    s_mov_b32 s34, 0
    s_mov_b32 s30, 0x400000
    s_mov_b32 s31, 0x20000
    s_waitcnt lgkmcnt(0)
    s_add_u32 s28, s6, s49
    s_addc_u32 s29, s7, 0
    buffer_load_dwordx4 v[112:115], v2, s[28:31], s53 offen nt
    buffer_load_dwordx4 v[116:119], v5, s[28:31], s53 offen nt
    s_cmp_lt_u32 s27, 2
    s_cbranch_scc1 L_rolepro
    s_barrier
    s_mov_b32 s40, s12
    s_mov_b32 s41, s13
    s_mov_b32 s42, 0
    s_mov_b32 s43, 0x20000
    v_mov_b32 v120, 0
    v_and_b32 v22, 1, v1
    v_lshlrev_b32 v22, 4, v22
    v_mov_b32 v23, 0xffff
    v_lshlrev_b32 v22, v22, v23
    v_bfe_u32 v23, v1, 1, 3
    v_cmp_eq_u32 vcc, 0, v23
    s_nop 1
    v_cndmask_b32 v12, 0, v22, vcc
    v_cmp_eq_u32 vcc, 1, v23
    s_nop 1
    v_cndmask_b32 v13, 0, v22, vcc
    v_cmp_eq_u32 vcc, 2, v23
    s_nop 1
    v_cndmask_b32 v14, 0, v22, vcc
    v_cmp_eq_u32 vcc, 3, v23
    s_nop 1
    v_cndmask_b32 v15, 0, v22, vcc
    v_mov_b32 v16, 0
    v_mov_b32 v17, 0
    v_mov_b32 v18, 0
    v_mov_b32 v19, 0
    v_and_b32 v24, 15, v1
    v_lshlrev_b32 v24, 4, v24
    v_add_u32 v24, 133120, v24
    v_lshlrev_b32 v3, 4, v0
    v_add_u32 v3, 137728, v3
    v_mov_b32 v4, 133568
    v_mov_b32 v6, 0
    s_lshl_b32 s49, s26, 22
    s_add_u32 s32, s8, s49
    s_addc_u32 s33, s9, 0
    s_cmp_lt_u32 s27, 2
    s_cselect_b32 s58, 0x33333333, 0
    s_cselect_b32 s61, 3, 9
    s_mov_b32 s59, s58
    s_mov_b32 s64, 0x00110011
    s_mov_b32 s65, 0x00110011
    s_mov_b32 s66, 0x22222222
    s_mov_b32 s67, 0x22222222
    s_mov_b32 s68, 0x44444444
    s_mov_b32 s69, 0x44444444
    s_mov_b32 s70, 0x88888888
    s_mov_b32 s71, 0x88888888
    s_mov_b32 s36, s24
    s_mov_b32 s37, s25
    s_mov_b32 s38, 2097152
    s_mov_b32 s39, 0x20000
    s_mov_b32 s51, 0
    s_waitcnt vmcnt(2)
    buffer_load_dwordx4 v[48:51], v2, s[28:31], s48 offen offset:0 nt
    s_waitcnt vmcnt(2)
    buffer_load_dwordx4 v[52:55], v5, s[28:31], s48 offen offset:0 nt
    s_waitcnt vmcnt(2)
    buffer_load_dwordx4 v[56:59], v2, s[28:31], s48 offen offset:2048 nt
    s_waitcnt vmcnt(2)
    buffer_load_dwordx4 v[60:63], v5, s[28:31], s48 offen offset:2048 nt
    s_add_u32 s48, s48, 0x8000
    s_waitcnt vmcnt(2)
    buffer_load_dwordx4 v[64:67], v2, s[28:31], s48 offen offset:0 nt
    s_waitcnt vmcnt(2)
    buffer_load_dwordx4 v[68:71], v5, s[28:31], s48 offen offset:0 nt
    s_waitcnt vmcnt(2)
    buffer_load_dwordx4 v[72:75], v2, s[28:31], s48 offen offset:2048 nt
    s_waitcnt vmcnt(2)
    buffer_load_dwordx4 v[76:79], v5, s[28:31], s48 offen offset:2048 nt
    s_add_u32 s48, s48, 0x8000
    s_branch L_pro2
L_rolepro:
    s_barrier
    v_and_b32 v22, 7, v1
    v_lshrrev_b32 v23, 4, v1
    v_lshlrev_b32 v23, 1, v23
    v_xor_b32 v22, v22, v23
    v_lshlrev_b32 v120, 4, v22
    s_lshl_b32 s55, s3, 13
    s_movk_i32 s91, 0x400
    s_cmp_eq_u32 s27, 1
    s_cbranch_scc1 L_ffnpro
    s_mov_b32 s40, s12
    s_mov_b32 s41, s13
    s_mov_b32 s42, 4194304
    s_mov_b32 s43, 0x20000
    v_lshrrev_b32 v23, 3, v1
    v_lshl_add_u32 v120, v23, 10, v120
    s_lshr_b32 s54, s26, 3
    s_lshl_b32 s54, s54, 20
    s_and_b32 s49, s26, 7
    s_lshl_b32 s49, s49, 7
    s_add_u32 s54, s54, s49
    s_lshl_b32 s49, s3, 16
    s_add_u32 s54, s54, s49
    s_movk_i32 s88, 0x2000
    s_movk_i32 s89, 0x4000
    s_mov_b32 s90, 0x8000
    s_branch L_rolego
L_ffnpro:
    s_mov_b32 s40, s16
    s_mov_b32 s41, s17
    s_mov_b32 s42, 1835008
    s_mov_b32 s43, 0x20000
    s_cmp_ge_u32 s26, 28
    s_cselect_b32 s92, 0x7ff00000, 0
    v_lshrrev_b32 v23, 3, v1
    v_mul_u32_u24 v23, 3584, v23
    v_add3_u32 v120, v120, v23, s92
    s_lshl_b32 s54, s26, 7
    s_mul_i32 s49, s3, 229376
    s_add_u32 s54, s54, s49
    s_mov_b32 s88, 28672
    s_mov_b32 s89, 57344
    s_mov_b32 s90, 114688
L_rolego:
    s_lshl_b32 s94, s91, 1
    s_lshl_b32 s95, s91, 2
    s_mov_b32 s56, s54
    s_mov_b32 s57, s55
    s_mov_b32 s49, s54
    s_mov_b32 m0, s55
    s_waitcnt vmcnt(2)
    buffer_load_dwordx4 v120, s[40:43], s49 offen nt lds
    s_add_u32 s49, s54, s88
    s_add_u32 m0, s55, s91
    s_waitcnt vmcnt(2)
    buffer_load_dwordx4 v120, s[40:43], s49 offen nt lds
    s_add_u32 s49, s54, s89
    s_add_u32 m0, s55, s94
    s_waitcnt vmcnt(2)
    buffer_load_dwordx4 v120, s[40:43], s49 offen nt lds
    s_add_u32 s49, s49, s88
    s_add_u32 m0, m0, s91
    s_waitcnt vmcnt(2)
    buffer_load_dwordx4 v120, s[40:43], s49 offen nt lds
    s_add_u32 s54, s54, s90
    s_add_u32 s55, s55, s95
    s_add_u32 s48, s48, 0x8000
    v_and_b32 v22, 1, v1
    v_lshlrev_b32 v22, 4, v22
    v_mov_b32 v23, 0xffff
    v_lshlrev_b32 v22, v22, v23
    v_bfe_u32 v23, v1, 1, 3
    v_cmp_eq_u32 vcc, 0, v23
    s_nop 1
    v_cndmask_b32 v12, 0, v22, vcc
    v_cmp_eq_u32 vcc, 1, v23
    s_nop 1
    v_cndmask_b32 v13, 0, v22, vcc
    v_cmp_eq_u32 vcc, 2, v23
    s_nop 1
    v_cndmask_b32 v14, 0, v22, vcc
    v_cmp_eq_u32 vcc, 3, v23
    s_nop 1
    v_cndmask_b32 v15, 0, v22, vcc
    v_mov_b32 v16, 0
    v_mov_b32 v17, 0
    v_mov_b32 v18, 0
    v_mov_b32 v19, 0
    v_and_b32 v24, 15, v1
    v_lshlrev_b32 v24, 4, v24
    v_add_u32 v24, 133120, v24
    v_lshlrev_b32 v3, 4, v0
    v_add_u32 v3, 137728, v3
    v_mov_b32 v4, 133568
    v_mov_b32 v6, 0
    s_lshl_b32 s49, s26, 22
    s_add_u32 s32, s8, s49
    s_addc_u32 s33, s9, 0
    s_cmp_lt_u32 s27, 2
    s_cselect_b32 s58, 0x33333333, 0
    s_cselect_b32 s61, 3, 9
    s_mov_b32 s59, s58
    s_mov_b32 s64, 0x00110011
    s_mov_b32 s65, 0x00110011
    s_mov_b32 s66, 0x22222222
    s_mov_b32 s67, 0x22222222
    s_mov_b32 s68, 0x44444444
    s_mov_b32 s69, 0x44444444
    s_mov_b32 s70, 0x88888888
    s_mov_b32 s71, 0x88888888
    s_mov_b32 s36, s24
    s_mov_b32 s37, s25
    s_mov_b32 s38, 2097152
    s_mov_b32 s39, 0x20000
    s_mov_b32 s51, 0
    s_mov_b32 s49, s54
    s_mov_b32 m0, s55
    s_waitcnt vmcnt(2)
    buffer_load_dwordx4 v120, s[40:43], s49 offen nt lds
    s_add_u32 s49, s54, s88
    s_add_u32 m0, s55, s91
    s_waitcnt vmcnt(2)
    buffer_load_dwordx4 v120, s[40:43], s49 offen nt lds
    s_add_u32 s49, s54, s89
    s_add_u32 m0, s55, s94
    s_waitcnt vmcnt(2)
    buffer_load_dwordx4 v120, s[40:43], s49 offen nt lds
    s_add_u32 s49, s49, s88
    s_add_u32 m0, m0, s91
    s_waitcnt vmcnt(2)
    buffer_load_dwordx4 v120, s[40:43], s49 offen nt lds
    s_add_u32 s54, s54, s90
    s_add_u32 s55, s55, s95
    s_add_u32 s48, s48, 0x8000
    s_cmp_eq_u32 s27, 1
    s_cbranch_scc1 L_ffn2
    s_add_u32 s54, s56, 524288
    s_add_u32 s55, s57, 0x10000
    s_branch L_pro2
L_ffn2:
    s_mov_b32 s40, s18
    s_mov_b32 s41, s19
    s_mov_b32 s42, 1835008
    s_mov_b32 s43, 0x20000
    v_lshl_add_u32 v120, v1, 4, s92
    s_min_u32 s54, s26, 27
    s_lshl_b32 s54, s54, 16
    s_lshl_b32 s49, s3, 13
    s_add_u32 s54, s54, s49
    s_mul_i32 s55, s3, 8448
    s_add_u32 s55, s55, 65536
    s_movk_i32 s91, 1056
    s_movk_i32 s88, 0x400
    s_movk_i32 s89, 0x800
    s_movk_i32 s90, 0x1000
    s_lshl_b32 s94, s91, 1
    s_lshl_b32 s95, s91, 2
L_pro2:
    ds_write_b32 v4, v6 offset:4
    s_waitcnt vmcnt(2)
    buffer_load_dwordx4 v[80:83], v2, s[28:31], s48 offen offset:0 nt
    s_waitcnt vmcnt(2)
    buffer_load_dwordx4 v[84:87], v5, s[28:31], s48 offen offset:0 nt
    s_waitcnt vmcnt(2)
    buffer_load_dwordx4 v[88:91], v2, s[28:31], s48 offen offset:2048 nt
    s_waitcnt vmcnt(2)
    buffer_load_dwordx4 v[92:95], v5, s[28:31], s48 offen offset:2048 nt
    s_add_u32 s48, s48, 0x8000
    s_waitcnt vmcnt(2)
    buffer_load_dwordx4 v[96:99], v2, s[28:31], s48 offen offset:0 nt
    s_waitcnt vmcnt(2)
    buffer_load_dwordx4 v[100:103], v5, s[28:31], s48 offen offset:0 nt
    s_waitcnt vmcnt(2)
    buffer_load_dwordx4 v[104:107], v2, s[28:31], s48 offen offset:2048 nt
    s_waitcnt vmcnt(2)
    buffer_load_dwordx4 v[108:111], v5, s[28:31], s48 offen offset:2048 nt
    s_add_u32 s34, s34, 1
    s_and_b32 s48, s34, 1
    s_lshl_b32 s48, s48, 17
    s_bfe_u32 s35, s34, 0x10001
    s_lshl_b32 s35, s35, 18
    s_add_u32 s48, s48, s35
    s_add_u32 s48, s48, s93
    v_xor_b32 v2, 0x2000, v2
    v_xor_b32 v5, 0x2000, v5
L_qwait:
    s_sub_u32 s62, s62, 1
    s_cmp_lt_i32 s62, 0
    s_cbranch_scc1 L_qwaitgo
    ds_read_b32 v25, v4 offset:48
    ds_read_b128 v[8:11], v24
    s_waitcnt lgkmcnt(0)
    v_cmp_eq_u32 vcc, -1, v25
    s_cbranch_vccnz L_qwait
L_qwaitgo:
    v_dot2_f32_bf16 v24, v112, v8, 0
    v_dot2_f32_bf16 v25, v116, v8, 0
    v_dot2_f32_bf16 v24, v113, v9, v24
    v_dot2_f32_bf16 v25, v117, v9, v25
    v_dot2_f32_bf16 v24, v114, v10, v24
    v_dot2_f32_bf16 v25, v118, v10, v25
    v_dot2_f32_bf16 v24, v115, v11, v24
    v_dot2_f32_bf16 v25, v119, v11, v25
    s_nop 1
    v_add_f32_dpp v24, v24, v24 quad_perm:[1,0,3,2] row_mask:0xf bank_mask:0xf
    v_add_f32_dpp v25, v25, v25 quad_perm:[1,0,3,2] row_mask:0xf bank_mask:0xf
    s_nop 0
    v_add_f32_dpp v24, v24, v24 quad_perm:[2,3,0,1] row_mask:0xf bank_mask:0xf
    v_add_f32_dpp v25, v25, v25 quad_perm:[2,3,0,1] row_mask:0xf bank_mask:0xf
    s_nop 0
    v_add_f32_dpp v28, v24, v24 row_half_mirror row_mask:0xf bank_mask:0x5
    v_add_f32_dpp v28, v25, v25 row_half_mirror row_mask:0xf bank_mask:0xa
    s_nop 1
    v_add_f32_dpp v7, v28, v28 row_ror:8 row_mask:0xf bank_mask:0xf
    v_mov_b32 v121, 1
L_kloop:
    s_cmp_lg_u32 s51, 3
    s_cbranch_scc1 L_knosw
    s_mov_b32 s28, s32
    s_mov_b32 s29, s33
    s_mov_b32 s48, s93
    s_waitcnt vmcnt(2)
    buffer_load_dwordx4 v[112:115], v2, s[28:31], s53 offen nt
    s_waitcnt vmcnt(2)
    buffer_load_dwordx4 v[116:119], v5, s[28:31], s53 offen nt
L_knosw:
    ds_read_b32 v31, v4 offset:12
    v_dot2_f32_bf16 v24, v48, v8, 0
    v_dot2_f32_bf16 v25, v52, v8, 0
    v_dot2_f32_bf16 v26, v56, v8, 0
    v_dot2_f32_bf16 v27, v60, v8, 0
    v_dot2_f32_bf16 v24, v49, v9, v24
    v_dot2_f32_bf16 v25, v53, v9, v25
    v_dot2_f32_bf16 v26, v57, v9, v26
    v_dot2_f32_bf16 v27, v61, v9, v27
    v_dot2_f32_bf16 v24, v50, v10, v24
    v_dot2_f32_bf16 v25, v54, v10, v25
    v_dot2_f32_bf16 v26, v58, v10, v26
    v_dot2_f32_bf16 v27, v62, v10, v27
    v_dot2_f32_bf16 v24, v51, v11, v24
    v_dot2_f32_bf16 v25, v55, v11, v25
    v_dot2_f32_bf16 v26, v59, v11, v26
    v_dot2_f32_bf16 v27, v63, v11, v27
    v_add_f32_dpp v24, v24, v24 quad_perm:[1,0,3,2] row_mask:0xf bank_mask:0xf
    v_add_f32_dpp v25, v25, v25 quad_perm:[1,0,3,2] row_mask:0xf bank_mask:0xf
    v_add_f32_dpp v26, v26, v26 quad_perm:[1,0,3,2] row_mask:0xf bank_mask:0xf
    v_add_f32_dpp v27, v27, v27 quad_perm:[1,0,3,2] row_mask:0xf bank_mask:0xf
    v_add_f32_dpp v24, v24, v24 quad_perm:[2,3,0,1] row_mask:0xf bank_mask:0xf
    v_add_f32_dpp v25, v25, v25 quad_perm:[2,3,0,1] row_mask:0xf bank_mask:0xf
    v_add_f32_dpp v26, v26, v26 quad_perm:[2,3,0,1] row_mask:0xf bank_mask:0xf
    v_add_f32_dpp v27, v27, v27 quad_perm:[2,3,0,1] row_mask:0xf bank_mask:0xf
    v_add_f32_dpp v28, v24, v24 row_half_mirror row_mask:0xf bank_mask:0x5
    v_add_f32_dpp v29, v26, v26 row_half_mirror row_mask:0xf bank_mask:0x5
    v_add_f32_dpp v28, v25, v25 row_half_mirror row_mask:0xf bank_mask:0xa
    v_add_f32_dpp v29, v27, v27 row_half_mirror row_mask:0xf bank_mask:0xa
    v_mov_b32 v20, v21
    v_mov_b32 v21, v22
    v_mov_b32 v22, v23
    v_add_f32_dpp v23, v28, v28 row_ror:8 row_mask:0xf bank_mask:0x3
    v_add_f32_dpp v23, v29, v29 row_ror:8 row_mask:0xf bank_mask:0xc
    s_cmp_eq_u32 s51, s61
    s_cbranch_scc1 L_kdma0
    s_waitcnt lgkmcnt(0)
    v_cmp_eq_u32 vcc, -1, v31
    s_cbranch_vccz L_thrk0
    s_waitcnt vmcnt(2)
    buffer_load_dwordx4 v[48:51], v2, s[28:31], s48 offen offset:0 nt
    s_waitcnt vmcnt(2)
    buffer_load_dwordx4 v[52:55], v5, s[28:31], s48 offen offset:0 nt
    s_waitcnt vmcnt(2)
    buffer_load_dwordx4 v[56:59], v2, s[28:31], s48 offen offset:2048 nt
    s_waitcnt vmcnt(2)
    buffer_load_dwordx4 v[60:63], v5, s[28:31], s48 offen offset:2048 nt
    s_add_u32 s48, s48, 0x8000
L_thrbk0:
    s_mov_b64 exec, 1
    ds_add_u32 v4, v121 offset:16
    s_mov_b64 exec, -1
    ds_read_b32 v31, v4 offset:12
    v_dot2_f32_bf16 v24, v64, v8, 0
    v_dot2_f32_bf16 v25, v68, v8, 0
    v_dot2_f32_bf16 v26, v72, v8, 0
    v_dot2_f32_bf16 v27, v76, v8, 0
    v_dot2_f32_bf16 v24, v65, v9, v24
    v_dot2_f32_bf16 v25, v69, v9, v25
    v_dot2_f32_bf16 v26, v73, v9, v26
    v_dot2_f32_bf16 v27, v77, v9, v27
    v_dot2_f32_bf16 v24, v66, v10, v24
    v_dot2_f32_bf16 v25, v70, v10, v25
    v_dot2_f32_bf16 v26, v74, v10, v26
    v_dot2_f32_bf16 v27, v78, v10, v27
    v_dot2_f32_bf16 v24, v67, v11, v24
    v_dot2_f32_bf16 v25, v71, v11, v25
    v_dot2_f32_bf16 v26, v75, v11, v26
    v_dot2_f32_bf16 v27, v79, v11, v27
    v_add_f32_dpp v24, v24, v24 quad_perm:[1,0,3,2] row_mask:0xf bank_mask:0xf
    v_add_f32_dpp v25, v25, v25 quad_perm:[1,0,3,2] row_mask:0xf bank_mask:0xf
    v_add_f32_dpp v26, v26, v26 quad_perm:[1,0,3,2] row_mask:0xf bank_mask:0xf
    v_add_f32_dpp v27, v27, v27 quad_perm:[1,0,3,2] row_mask:0xf bank_mask:0xf
    v_add_f32_dpp v24, v24, v24 quad_perm:[2,3,0,1] row_mask:0xf bank_mask:0xf
    v_add_f32_dpp v25, v25, v25 quad_perm:[2,3,0,1] row_mask:0xf bank_mask:0xf
    v_add_f32_dpp v26, v26, v26 quad_perm:[2,3,0,1] row_mask:0xf bank_mask:0xf
    v_add_f32_dpp v27, v27, v27 quad_perm:[2,3,0,1] row_mask:0xf bank_mask:0xf
    v_add_f32_dpp v28, v24, v24 row_half_mirror row_mask:0xf bank_mask:0x5
    v_add_f32_dpp v29, v26, v26 row_half_mirror row_mask:0xf bank_mask:0x5
    v_add_f32_dpp v28, v25, v25 row_half_mirror row_mask:0xf bank_mask:0xa
    v_add_f32_dpp v29, v27, v27 row_half_mirror row_mask:0xf bank_mask:0xa
    s_nop 0
    v_add_f32_dpp v30, v28, v28 row_ror:8 row_mask:0xf bank_mask:0x3
    v_add_f32_dpp v30, v29, v29 row_ror:8 row_mask:0xf bank_mask:0xc
    v_cndmask_b32 v23, v23, v30, s[66:67]
    s_cmp_eq_u32 s51, s61
    s_cbranch_scc1 L_kdma1
    s_waitcnt lgkmcnt(0)
    v_cmp_eq_u32 vcc, -1, v31
    s_cbranch_vccz L_thrk1
    s_waitcnt vmcnt(2)
    buffer_load_dwordx4 v[64:67], v2, s[28:31], s48 offen offset:0 nt
    s_waitcnt vmcnt(2)
    buffer_load_dwordx4 v[68:71], v5, s[28:31], s48 offen offset:0 nt
    s_waitcnt vmcnt(2)
    buffer_load_dwordx4 v[72:75], v2, s[28:31], s48 offen offset:2048 nt
    s_waitcnt vmcnt(2)
    buffer_load_dwordx4 v[76:79], v5, s[28:31], s48 offen offset:2048 nt
    s_add_u32 s48, s48, 0x8000
L_thrbk1:
    s_mov_b64 exec, 1
    ds_add_u32 v4, v121 offset:16
    s_mov_b64 exec, -1
    ds_read_b32 v31, v4 offset:12
    v_dot2_f32_bf16 v24, v80, v8, 0
    v_dot2_f32_bf16 v25, v84, v8, 0
    v_dot2_f32_bf16 v26, v88, v8, 0
    v_dot2_f32_bf16 v27, v92, v8, 0
    v_dot2_f32_bf16 v24, v81, v9, v24
    v_dot2_f32_bf16 v25, v85, v9, v25
    v_dot2_f32_bf16 v26, v89, v9, v26
    v_dot2_f32_bf16 v27, v93, v9, v27
    v_dot2_f32_bf16 v24, v82, v10, v24
    v_dot2_f32_bf16 v25, v86, v10, v25
    v_dot2_f32_bf16 v26, v90, v10, v26
    v_dot2_f32_bf16 v27, v94, v10, v27
    v_dot2_f32_bf16 v24, v83, v11, v24
    v_dot2_f32_bf16 v25, v87, v11, v25
    v_dot2_f32_bf16 v26, v91, v11, v26
    v_dot2_f32_bf16 v27, v95, v11, v27
    v_add_f32_dpp v24, v24, v24 quad_perm:[1,0,3,2] row_mask:0xf bank_mask:0xf
    v_add_f32_dpp v25, v25, v25 quad_perm:[1,0,3,2] row_mask:0xf bank_mask:0xf
    v_add_f32_dpp v26, v26, v26 quad_perm:[1,0,3,2] row_mask:0xf bank_mask:0xf
    v_add_f32_dpp v27, v27, v27 quad_perm:[1,0,3,2] row_mask:0xf bank_mask:0xf
    v_add_f32_dpp v24, v24, v24 quad_perm:[2,3,0,1] row_mask:0xf bank_mask:0xf
    v_add_f32_dpp v25, v25, v25 quad_perm:[2,3,0,1] row_mask:0xf bank_mask:0xf
    v_add_f32_dpp v26, v26, v26 quad_perm:[2,3,0,1] row_mask:0xf bank_mask:0xf
    v_add_f32_dpp v27, v27, v27 quad_perm:[2,3,0,1] row_mask:0xf bank_mask:0xf
    v_add_f32_dpp v28, v24, v24 row_half_mirror row_mask:0xf bank_mask:0x5
    v_add_f32_dpp v29, v26, v26 row_half_mirror row_mask:0xf bank_mask:0x5
    v_add_f32_dpp v28, v25, v25 row_half_mirror row_mask:0xf bank_mask:0xa
    v_add_f32_dpp v29, v27, v27 row_half_mirror row_mask:0xf bank_mask:0xa
    s_nop 0
    v_add_f32_dpp v30, v28, v28 row_ror:8 row_mask:0xf bank_mask:0x3
    v_add_f32_dpp v30, v29, v29 row_ror:8 row_mask:0xf bank_mask:0xc
    v_cndmask_b32 v23, v23, v30, s[68:69]
    s_waitcnt lgkmcnt(0)
    v_cmp_eq_u32 vcc, -1, v31
    s_cbranch_vccz L_thrk2
    s_waitcnt vmcnt(2)
    buffer_load_dwordx4 v[80:83], v2, s[28:31], s48 offen offset:0 nt
    s_waitcnt vmcnt(2)
    buffer_load_dwordx4 v[84:87], v5, s[28:31], s48 offen offset:0 nt
    s_waitcnt vmcnt(2)
    buffer_load_dwordx4 v[88:91], v2, s[28:31], s48 offen offset:2048 nt
    s_waitcnt vmcnt(2)
    buffer_load_dwordx4 v[92:95], v5, s[28:31], s48 offen offset:2048 nt
    s_add_u32 s48, s48, 0x8000
L_thrbk2:
    s_mov_b64 exec, 1
    ds_add_u32 v4, v121 offset:16
    s_mov_b64 exec, -1
    ds_read_b32 v31, v4 offset:12
    v_dot2_f32_bf16 v24, v96, v8, 0
    v_dot2_f32_bf16 v25, v100, v8, 0
    v_dot2_f32_bf16 v26, v104, v8, 0
    v_dot2_f32_bf16 v27, v108, v8, 0
    v_dot2_f32_bf16 v24, v97, v9, v24
    v_dot2_f32_bf16 v25, v101, v9, v25
    v_dot2_f32_bf16 v26, v105, v9, v26
    v_dot2_f32_bf16 v27, v109, v9, v27
    v_dot2_f32_bf16 v24, v98, v10, v24
    v_dot2_f32_bf16 v25, v102, v10, v25
    v_dot2_f32_bf16 v26, v106, v10, v26
    v_dot2_f32_bf16 v27, v110, v10, v27
    v_dot2_f32_bf16 v24, v99, v11, v24
    v_dot2_f32_bf16 v25, v103, v11, v25
    v_dot2_f32_bf16 v26, v107, v11, v26
    v_dot2_f32_bf16 v27, v111, v11, v27
    v_add_f32_dpp v24, v24, v24 quad_perm:[1,0,3,2] row_mask:0xf bank_mask:0xf
    v_add_f32_dpp v25, v25, v25 quad_perm:[1,0,3,2] row_mask:0xf bank_mask:0xf
    v_add_f32_dpp v26, v26, v26 quad_perm:[1,0,3,2] row_mask:0xf bank_mask:0xf
    v_add_f32_dpp v27, v27, v27 quad_perm:[1,0,3,2] row_mask:0xf bank_mask:0xf
    v_add_f32_dpp v24, v24, v24 quad_perm:[2,3,0,1] row_mask:0xf bank_mask:0xf
    v_add_f32_dpp v25, v25, v25 quad_perm:[2,3,0,1] row_mask:0xf bank_mask:0xf
    v_add_f32_dpp v26, v26, v26 quad_perm:[2,3,0,1] row_mask:0xf bank_mask:0xf
    v_add_f32_dpp v27, v27, v27 quad_perm:[2,3,0,1] row_mask:0xf bank_mask:0xf
    v_add_f32_dpp v28, v24, v24 row_half_mirror row_mask:0xf bank_mask:0x5
    v_add_f32_dpp v29, v26, v26 row_half_mirror row_mask:0xf bank_mask:0x5
    v_add_f32_dpp v28, v25, v25 row_half_mirror row_mask:0xf bank_mask:0xa
    v_add_f32_dpp v29, v27, v27 row_half_mirror row_mask:0xf bank_mask:0xa
    s_nop 0
    v_add_f32_dpp v30, v28, v28 row_ror:8 row_mask:0xf bank_mask:0x3
    v_add_f32_dpp v30, v29, v29 row_ror:8 row_mask:0xf bank_mask:0xc
    v_cndmask_b32 v23, v23, v30, s[70:71]
    s_waitcnt lgkmcnt(0)
    v_cmp_eq_u32 vcc, -1, v31
    s_cbranch_vccz L_thrk3
    s_waitcnt vmcnt(2)
    buffer_load_dwordx4 v[96:99], v2, s[28:31], s48 offen offset:0 nt
    s_waitcnt vmcnt(2)
    buffer_load_dwordx4 v[100:103], v5, s[28:31], s48 offen offset:0 nt
    s_waitcnt vmcnt(2)
    buffer_load_dwordx4 v[104:107], v2, s[28:31], s48 offen offset:2048 nt
    s_waitcnt vmcnt(2)
    buffer_load_dwordx4 v[108:111], v5, s[28:31], s48 offen offset:2048 nt
    s_add_u32 s34, s34, 1
    s_and_b32 s48, s34, 1
    s_lshl_b32 s48, s48, 17
    s_bfe_u32 s35, s34, 0x10001
    s_lshl_b32 s35, s35, 18
    s_add_u32 s48, s48, s35
    s_add_u32 s48, s48, s93
    v_xor_b32 v2, 0x2000, v2
    v_xor_b32 v5, 0x2000, v5
L_thrbk3:
    s_mov_b64 exec, 1
    ds_add_u32 v4, v121 offset:16
    s_mov_b64 exec, -1
    s_add_u32 s51, s51, 1
    s_cmp_lt_u32 s51, 4
    s_cbranch_scc1 L_kloop
    v_cvt_pk_bf16_f32 v24, v20, v21
    v_cvt_pk_bf16_f32 v25, v22, v23
    v_cvt_pk_bf16_f32 v7, v7, v7
    v_lshlrev_b32 v20, 16, v24
    v_and_b32 v21, 0xffff0000, v24
    v_lshlrev_b32 v22, 16, v25
    v_and_b32 v23, 0xffff0000, v25
    v_lshlrev_b32 v7, 16, v7
    v_mul_f32 v20, 0x3db504f3, v20
    v_mul_f32 v21, 0x3db504f3, v21
    v_mul_f32 v22, 0x3db504f3, v22
    v_mul_f32 v23, 0x3db504f3, v23
    v_mul_f32 v7, 0x3db504f3, v7
    v_cvt_pk_bf16_f32 v24, v20, v21
    v_cvt_pk_bf16_f32 v25, v22, v23
    v_cvt_pk_bf16_f32 v7, v7, v7
    v_lshlrev_b32 v20, 16, v24
    v_and_b32 v21, 0xffff0000, v24
    v_lshlrev_b32 v22, 16, v25
    v_and_b32 v23, 0xffff0000, v25
    v_lshlrev_b32 v7, 16, v7
    v_mul_f32 v20, 0x3fb8aa3b, v20
    v_mul_f32 v21, 0x3fb8aa3b, v21
    v_mul_f32 v22, 0x3fb8aa3b, v22
    v_mul_f32 v23, 0x3fb8aa3b, v23
    v_mul_f32 v7, 0x3fb8aa3b, v7
    v_mov_b32 v26, 0xff800000
    v_cndmask_b32 v20, v20, v26, s[58:59]
    v_cndmask_b32 v7, v26, v7, s[64:65]
    v_max3_f32 v24, v20, v21, v22
    v_max3_f32 v24, v24, v23, v7
    s_nop 1
    v_max_f32_dpp v24, v24, v24 quad_perm:[1,0,3,2] row_mask:0xf bank_mask:0xf
    s_nop 1
    v_max_f32_dpp v24, v24, v24 quad_perm:[2,3,0,1] row_mask:0xf bank_mask:0xf
    s_nop 1
    v_max_f32_dpp v24, v24, v24 row_half_mirror row_mask:0xf bank_mask:0xf
    s_nop 1
    v_max_f32_dpp v24, v24, v24 row_mirror row_mask:0xf bank_mask:0xf
    s_nop 1
    v_max_f32_dpp v24, v24, v24 row_bcast:15 row_mask:0xa bank_mask:0xf
    s_nop 1
    v_max_f32_dpp v24, v24, v24 row_bcast:31 row_mask:0xc bank_mask:0xf
    s_nop 0
    v_readlane_b32 s56, v24, 63
    s_nop 1
    v_subrev_f32 v20, s56, v20
    v_subrev_f32 v21, s56, v21
    v_subrev_f32 v22, s56, v22
    v_subrev_f32 v23, s56, v23
    v_subrev_f32 v7, s56, v7
    v_exp_f32 v20, v20
    v_exp_f32 v21, v21
    v_exp_f32 v22, v22
    v_exp_f32 v23, v23
    v_exp_f32 v7, v7
    v_add_f32 v25, v20, v21
    v_add_f32 v26, v22, v23
    v_add_f32 v25, v25, v26
    v_add_f32 v25, v25, v7
    v_cvt_pk_bf16_f32 v20, v20, v20
    v_cvt_pk_bf16_f32 v21, v21, v21
    v_cvt_pk_bf16_f32 v22, v22, v22
    v_cvt_pk_bf16_f32 v23, v23, v23
    v_cvt_pk_bf16_f32 v7, v7, v7
    v_add_f32_dpp v25, v25, v25 quad_perm:[1,0,3,2] row_mask:0xf bank_mask:0xf
    s_nop 1
    v_add_f32_dpp v25, v25, v25 quad_perm:[2,3,0,1] row_mask:0xf bank_mask:0xf
    s_nop 1
    v_add_f32_dpp v25, v25, v25 row_half_mirror row_mask:0xf bank_mask:0xf
    s_nop 1
    v_add_f32_dpp v25, v25, v25 row_mirror row_mask:0xf bank_mask:0xf
    s_nop 1
    v_add_f32_dpp v25, v25, v25 row_bcast:15 row_mask:0xa bank_mask:0xf
    s_nop 1
    v_add_f32_dpp v25, v25, v25 row_bcast:31 row_mask:0xc bank_mask:0xf
    v_and_b32_dpp v32, v7, v12 row_newbcast:0 row_mask:0xf bank_mask:0xf
    v_and_b32_dpp v33, v7, v13 row_newbcast:0 row_mask:0xf bank_mask:0xf
    v_and_b32_dpp v34, v7, v14 row_newbcast:0 row_mask:0xf bank_mask:0xf
    v_and_b32_dpp v35, v7, v15 row_newbcast:0 row_mask:0xf bank_mask:0xf
    v_and_b32_dpp v36, v7, v12 row_newbcast:4 row_mask:0xf bank_mask:0xf
    v_and_b32_dpp v37, v7, v13 row_newbcast:4 row_mask:0xf bank_mask:0xf
    v_and_b32_dpp v38, v7, v14 row_newbcast:4 row_mask:0xf bank_mask:0xf
    v_and_b32_dpp v39, v7, v15 row_newbcast:4 row_mask:0xf bank_mask:0xf
    v_mfma_f32_16x16x32_bf16 v[16:19], v[112:115], v[32:35], v[16:19]
    s_nop 0
    v_mfma_f32_16x16x32_bf16 v[16:19], v[116:119], v[36:39], v[16:19]
    v_and_b32_dpp v32, v20, v12 row_newbcast:0 row_mask:0xf bank_mask:0xf
    v_and_b32_dpp v33, v20, v13 row_newbcast:0 row_mask:0xf bank_mask:0xf
    v_and_b32_dpp v34, v20, v14 row_newbcast:0 row_mask:0xf bank_mask:0xf
    v_and_b32_dpp v35, v20, v15 row_newbcast:0 row_mask:0xf bank_mask:0xf
    v_and_b32_dpp v36, v20, v12 row_newbcast:4 row_mask:0xf bank_mask:0xf
    v_and_b32_dpp v37, v20, v13 row_newbcast:4 row_mask:0xf bank_mask:0xf
    v_and_b32_dpp v38, v20, v14 row_newbcast:4 row_mask:0xf bank_mask:0xf
    v_and_b32_dpp v39, v20, v15 row_newbcast:4 row_mask:0xf bank_mask:0xf
    v_and_b32_dpp v40, v20, v12 row_newbcast:8 row_mask:0xf bank_mask:0xf
    v_and_b32_dpp v41, v20, v13 row_newbcast:8 row_mask:0xf bank_mask:0xf
    v_and_b32_dpp v42, v20, v14 row_newbcast:8 row_mask:0xf bank_mask:0xf
    v_and_b32_dpp v43, v20, v15 row_newbcast:8 row_mask:0xf bank_mask:0xf
    v_and_b32_dpp v44, v20, v12 row_newbcast:12 row_mask:0xf bank_mask:0xf
    v_and_b32_dpp v45, v20, v13 row_newbcast:12 row_mask:0xf bank_mask:0xf
    v_and_b32_dpp v46, v20, v14 row_newbcast:12 row_mask:0xf bank_mask:0xf
    v_and_b32_dpp v47, v20, v15 row_newbcast:12 row_mask:0xf bank_mask:0xf
    s_lshl_b32 s57, s3, 3
    s_add_u32 s57, s57, 133504
    v_mov_b32 v26, s57
    v_min_u32 v24, -2, v24
    v_min_u32 v25, -2, v25
    s_mov_b32 exec_lo, 0x0
    s_mov_b32 exec_hi, 0x80000000
    ds_write_b64 v26, v[24:25]
    s_mov_b64 exec, -1
    s_mov_b32 s51, 0
L_vloop:
    ds_read_b32 v31, v4 offset:12
    v_mfma_f32_16x16x32_bf16 v[16:19], v[48:51], v[32:35], v[16:19]
    v_mfma_f32_16x16x32_bf16 v[16:19], v[52:55], v[36:39], v[16:19]
    v_mfma_f32_16x16x32_bf16 v[16:19], v[56:59], v[40:43], v[16:19]
    v_mfma_f32_16x16x32_bf16 v[16:19], v[60:63], v[44:47], v[16:19]
    v_and_b32_dpp v32, v20, v12 row_newbcast:1 row_mask:0xf bank_mask:0xf
    v_and_b32_dpp v33, v20, v13 row_newbcast:1 row_mask:0xf bank_mask:0xf
    v_and_b32_dpp v34, v20, v14 row_newbcast:1 row_mask:0xf bank_mask:0xf
    v_and_b32_dpp v35, v20, v15 row_newbcast:1 row_mask:0xf bank_mask:0xf
    v_and_b32_dpp v36, v20, v12 row_newbcast:5 row_mask:0xf bank_mask:0xf
    v_and_b32_dpp v37, v20, v13 row_newbcast:5 row_mask:0xf bank_mask:0xf
    v_and_b32_dpp v38, v20, v14 row_newbcast:5 row_mask:0xf bank_mask:0xf
    v_and_b32_dpp v39, v20, v15 row_newbcast:5 row_mask:0xf bank_mask:0xf
    v_and_b32_dpp v40, v20, v12 row_newbcast:9 row_mask:0xf bank_mask:0xf
    v_and_b32_dpp v41, v20, v13 row_newbcast:9 row_mask:0xf bank_mask:0xf
    v_and_b32_dpp v42, v20, v14 row_newbcast:9 row_mask:0xf bank_mask:0xf
    v_and_b32_dpp v43, v20, v15 row_newbcast:9 row_mask:0xf bank_mask:0xf
    v_and_b32_dpp v44, v20, v12 row_newbcast:13 row_mask:0xf bank_mask:0xf
    v_and_b32_dpp v45, v20, v13 row_newbcast:13 row_mask:0xf bank_mask:0xf
    v_and_b32_dpp v46, v20, v14 row_newbcast:13 row_mask:0xf bank_mask:0xf
    v_and_b32_dpp v47, v20, v15 row_newbcast:13 row_mask:0xf bank_mask:0xf
    s_waitcnt lgkmcnt(0)
    v_cmp_eq_u32 vcc, -1, v31
    s_cbranch_vccz L_thrv0
    s_waitcnt vmcnt(2)
    buffer_load_dwordx4 v[48:51], v2, s[28:31], s48 offen offset:0 nt
    s_waitcnt vmcnt(2)
    buffer_load_dwordx4 v[52:55], v5, s[28:31], s48 offen offset:0 nt
    s_waitcnt vmcnt(2)
    buffer_load_dwordx4 v[56:59], v2, s[28:31], s48 offen offset:2048 nt
    s_waitcnt vmcnt(2)
    buffer_load_dwordx4 v[60:63], v5, s[28:31], s48 offen offset:2048 nt
    s_add_u32 s48, s48, 0x8000
L_thrbv0:
    ds_read_b32 v31, v4 offset:12
    v_mfma_f32_16x16x32_bf16 v[16:19], v[64:67], v[32:35], v[16:19]
    v_mfma_f32_16x16x32_bf16 v[16:19], v[68:71], v[36:39], v[16:19]
    v_mfma_f32_16x16x32_bf16 v[16:19], v[72:75], v[40:43], v[16:19]
    v_mfma_f32_16x16x32_bf16 v[16:19], v[76:79], v[44:47], v[16:19]
    ds_write_b32 v4, v6
    v_and_b32_dpp v32, v20, v12 row_newbcast:2 row_mask:0xf bank_mask:0xf
    v_and_b32_dpp v33, v20, v13 row_newbcast:2 row_mask:0xf bank_mask:0xf
    v_and_b32_dpp v34, v20, v14 row_newbcast:2 row_mask:0xf bank_mask:0xf
    v_and_b32_dpp v35, v20, v15 row_newbcast:2 row_mask:0xf bank_mask:0xf
    v_and_b32_dpp v36, v20, v12 row_newbcast:6 row_mask:0xf bank_mask:0xf
    v_and_b32_dpp v37, v20, v13 row_newbcast:6 row_mask:0xf bank_mask:0xf
    v_and_b32_dpp v38, v20, v14 row_newbcast:6 row_mask:0xf bank_mask:0xf
    v_and_b32_dpp v39, v20, v15 row_newbcast:6 row_mask:0xf bank_mask:0xf
    v_and_b32_dpp v40, v20, v12 row_newbcast:10 row_mask:0xf bank_mask:0xf
    v_and_b32_dpp v41, v20, v13 row_newbcast:10 row_mask:0xf bank_mask:0xf
    v_and_b32_dpp v42, v20, v14 row_newbcast:10 row_mask:0xf bank_mask:0xf
    v_and_b32_dpp v43, v20, v15 row_newbcast:10 row_mask:0xf bank_mask:0xf
    v_and_b32_dpp v44, v20, v12 row_newbcast:14 row_mask:0xf bank_mask:0xf
    v_and_b32_dpp v45, v20, v13 row_newbcast:14 row_mask:0xf bank_mask:0xf
    v_and_b32_dpp v46, v20, v14 row_newbcast:14 row_mask:0xf bank_mask:0xf
    v_and_b32_dpp v47, v20, v15 row_newbcast:14 row_mask:0xf bank_mask:0xf
    s_waitcnt lgkmcnt(0)
    v_cmp_eq_u32 vcc, -1, v31
    s_cbranch_vccz L_thrv1
    s_waitcnt vmcnt(2)
    buffer_load_dwordx4 v[64:67], v2, s[28:31], s48 offen offset:0 nt
    s_waitcnt vmcnt(2)
    buffer_load_dwordx4 v[68:71], v5, s[28:31], s48 offen offset:0 nt
    s_waitcnt vmcnt(2)
    buffer_load_dwordx4 v[72:75], v2, s[28:31], s48 offen offset:2048 nt
    s_waitcnt vmcnt(2)
    buffer_load_dwordx4 v[76:79], v5, s[28:31], s48 offen offset:2048 nt
    s_add_u32 s48, s48, 0x8000
L_thrbv1:
    ds_read_b32 v31, v4 offset:12
    v_mfma_f32_16x16x32_bf16 v[16:19], v[80:83], v[32:35], v[16:19]
    v_mfma_f32_16x16x32_bf16 v[16:19], v[84:87], v[36:39], v[16:19]
    v_mfma_f32_16x16x32_bf16 v[16:19], v[88:91], v[40:43], v[16:19]
    v_mfma_f32_16x16x32_bf16 v[16:19], v[92:95], v[44:47], v[16:19]
    v_and_b32_dpp v32, v20, v12 row_newbcast:3 row_mask:0xf bank_mask:0xf
    v_and_b32_dpp v33, v20, v13 row_newbcast:3 row_mask:0xf bank_mask:0xf
    v_and_b32_dpp v34, v20, v14 row_newbcast:3 row_mask:0xf bank_mask:0xf
    v_and_b32_dpp v35, v20, v15 row_newbcast:3 row_mask:0xf bank_mask:0xf
    v_and_b32_dpp v36, v20, v12 row_newbcast:7 row_mask:0xf bank_mask:0xf
    v_and_b32_dpp v37, v20, v13 row_newbcast:7 row_mask:0xf bank_mask:0xf
    v_and_b32_dpp v38, v20, v14 row_newbcast:7 row_mask:0xf bank_mask:0xf
    v_and_b32_dpp v39, v20, v15 row_newbcast:7 row_mask:0xf bank_mask:0xf
    v_and_b32_dpp v40, v20, v12 row_newbcast:11 row_mask:0xf bank_mask:0xf
    v_and_b32_dpp v41, v20, v13 row_newbcast:11 row_mask:0xf bank_mask:0xf
    v_and_b32_dpp v42, v20, v14 row_newbcast:11 row_mask:0xf bank_mask:0xf
    v_and_b32_dpp v43, v20, v15 row_newbcast:11 row_mask:0xf bank_mask:0xf
    v_and_b32_dpp v44, v20, v12 row_newbcast:15 row_mask:0xf bank_mask:0xf
    v_and_b32_dpp v45, v20, v13 row_newbcast:15 row_mask:0xf bank_mask:0xf
    v_and_b32_dpp v46, v20, v14 row_newbcast:15 row_mask:0xf bank_mask:0xf
    v_and_b32_dpp v47, v20, v15 row_newbcast:15 row_mask:0xf bank_mask:0xf
    s_waitcnt lgkmcnt(0)
    v_cmp_eq_u32 vcc, -1, v31
    s_cbranch_vccz L_thrv2
    s_waitcnt vmcnt(2)
    buffer_load_dwordx4 v[80:83], v2, s[28:31], s48 offen offset:0 nt
    s_waitcnt vmcnt(2)
    buffer_load_dwordx4 v[84:87], v5, s[28:31], s48 offen offset:0 nt
    s_waitcnt vmcnt(2)
    buffer_load_dwordx4 v[88:91], v2, s[28:31], s48 offen offset:2048 nt
    s_waitcnt vmcnt(2)
    buffer_load_dwordx4 v[92:95], v5, s[28:31], s48 offen offset:2048 nt
    s_add_u32 s48, s48, 0x8000
L_thrbv2:
    ds_read_b32 v31, v4 offset:12
    v_mfma_f32_16x16x32_bf16 v[16:19], v[96:99], v[32:35], v[16:19]
    v_mfma_f32_16x16x32_bf16 v[16:19], v[100:103], v[36:39], v[16:19]
    v_mfma_f32_16x16x32_bf16 v[16:19], v[104:107], v[40:43], v[16:19]
    v_mfma_f32_16x16x32_bf16 v[16:19], v[108:111], v[44:47], v[16:19]
    v_mov_b32 v20, v21
    v_mov_b32 v21, v22
    v_mov_b32 v22, v23
    v_and_b32_dpp v32, v20, v12 row_newbcast:0 row_mask:0xf bank_mask:0xf
    v_and_b32_dpp v33, v20, v13 row_newbcast:0 row_mask:0xf bank_mask:0xf
    v_and_b32_dpp v34, v20, v14 row_newbcast:0 row_mask:0xf bank_mask:0xf
    v_and_b32_dpp v35, v20, v15 row_newbcast:0 row_mask:0xf bank_mask:0xf
    v_and_b32_dpp v36, v20, v12 row_newbcast:4 row_mask:0xf bank_mask:0xf
    v_and_b32_dpp v37, v20, v13 row_newbcast:4 row_mask:0xf bank_mask:0xf
    v_and_b32_dpp v38, v20, v14 row_newbcast:4 row_mask:0xf bank_mask:0xf
    v_and_b32_dpp v39, v20, v15 row_newbcast:4 row_mask:0xf bank_mask:0xf
    v_and_b32_dpp v40, v20, v12 row_newbcast:8 row_mask:0xf bank_mask:0xf
    v_and_b32_dpp v41, v20, v13 row_newbcast:8 row_mask:0xf bank_mask:0xf
    v_and_b32_dpp v42, v20, v14 row_newbcast:8 row_mask:0xf bank_mask:0xf
    v_and_b32_dpp v43, v20, v15 row_newbcast:8 row_mask:0xf bank_mask:0xf
    v_and_b32_dpp v44, v20, v12 row_newbcast:12 row_mask:0xf bank_mask:0xf
    v_and_b32_dpp v45, v20, v13 row_newbcast:12 row_mask:0xf bank_mask:0xf
    v_and_b32_dpp v46, v20, v14 row_newbcast:12 row_mask:0xf bank_mask:0xf
    v_and_b32_dpp v47, v20, v15 row_newbcast:12 row_mask:0xf bank_mask:0xf
    s_waitcnt lgkmcnt(0)
    v_cmp_eq_u32 vcc, -1, v31
    s_cbranch_vccz L_thrv3
    s_waitcnt vmcnt(2)
    buffer_load_dwordx4 v[96:99], v2, s[28:31], s48 offen offset:0 nt
    s_waitcnt vmcnt(2)
    buffer_load_dwordx4 v[100:103], v5, s[28:31], s48 offen offset:0 nt
    s_waitcnt vmcnt(2)
    buffer_load_dwordx4 v[104:107], v2, s[28:31], s48 offen offset:2048 nt
    s_waitcnt vmcnt(2)
    buffer_load_dwordx4 v[108:111], v5, s[28:31], s48 offen offset:2048 nt
    s_add_u32 s34, s34, 1
    s_and_b32 s48, s34, 1
    s_lshl_b32 s48, s48, 17
    s_bfe_u32 s35, s34, 0x10001
    s_lshl_b32 s35, s35, 18
    s_add_u32 s48, s48, s35
    s_add_u32 s48, s48, s93
    v_xor_b32 v2, 0x2000, v2
    v_xor_b32 v5, 0x2000, v5
L_thrbv3:
    s_add_u32 s51, s51, 1
    s_cmp_lt_u32 s51, 2
    s_cbranch_scc1 L_vloop
    v_mfma_f32_16x16x32_bf16 v[16:19], v[48:51], v[32:35], v[16:19]
    v_mfma_f32_16x16x32_bf16 v[16:19], v[52:55], v[36:39], v[16:19]
    v_mfma_f32_16x16x32_bf16 v[16:19], v[56:59], v[40:43], v[16:19]
    v_mfma_f32_16x16x32_bf16 v[16:19], v[60:63], v[44:47], v[16:19]
    v_and_b32_dpp v32, v20, v12 row_newbcast:1 row_mask:0xf bank_mask:0xf
    v_and_b32_dpp v33, v20, v13 row_newbcast:1 row_mask:0xf bank_mask:0xf
    v_and_b32_dpp v34, v20, v14 row_newbcast:1 row_mask:0xf bank_mask:0xf
    v_and_b32_dpp v35, v20, v15 row_newbcast:1 row_mask:0xf bank_mask:0xf
    v_and_b32_dpp v36, v20, v12 row_newbcast:5 row_mask:0xf bank_mask:0xf
    v_and_b32_dpp v37, v20, v13 row_newbcast:5 row_mask:0xf bank_mask:0xf
    v_and_b32_dpp v38, v20, v14 row_newbcast:5 row_mask:0xf bank_mask:0xf
    v_and_b32_dpp v39, v20, v15 row_newbcast:5 row_mask:0xf bank_mask:0xf
    v_and_b32_dpp v40, v20, v12 row_newbcast:9 row_mask:0xf bank_mask:0xf
    v_and_b32_dpp v41, v20, v13 row_newbcast:9 row_mask:0xf bank_mask:0xf
    v_and_b32_dpp v42, v20, v14 row_newbcast:9 row_mask:0xf bank_mask:0xf
    v_and_b32_dpp v43, v20, v15 row_newbcast:9 row_mask:0xf bank_mask:0xf
    v_and_b32_dpp v44, v20, v12 row_newbcast:13 row_mask:0xf bank_mask:0xf
    v_and_b32_dpp v45, v20, v13 row_newbcast:13 row_mask:0xf bank_mask:0xf
    v_and_b32_dpp v46, v20, v14 row_newbcast:13 row_mask:0xf bank_mask:0xf
    v_and_b32_dpp v47, v20, v15 row_newbcast:13 row_mask:0xf bank_mask:0xf
    s_waitcnt vmcnt(3)
    buffer_load_dwordx4 v[48:51], v2, s[28:31], s48 offen offset:0 nt
    s_waitcnt vmcnt(3)
    buffer_load_dwordx4 v[52:55], v5, s[28:31], s48 offen offset:0 nt
    s_waitcnt vmcnt(3)
    buffer_load_dwordx4 v[56:59], v2, s[28:31], s48 offen offset:2048 nt
    s_waitcnt vmcnt(3)
    buffer_load_dwordx4 v[60:63], v5, s[28:31], s48 offen offset:2048 nt
    s_add_u32 s48, s48, 0x8000
    v_mfma_f32_16x16x32_bf16 v[16:19], v[64:67], v[32:35], v[16:19]
    v_mfma_f32_16x16x32_bf16 v[16:19], v[68:71], v[36:39], v[16:19]
    v_mfma_f32_16x16x32_bf16 v[16:19], v[72:75], v[40:43], v[16:19]
    v_mfma_f32_16x16x32_bf16 v[16:19], v[76:79], v[44:47], v[16:19]
    v_and_b32_dpp v32, v20, v12 row_newbcast:2 row_mask:0xf bank_mask:0xf
    v_and_b32_dpp v33, v20, v13 row_newbcast:2 row_mask:0xf bank_mask:0xf
    v_and_b32_dpp v34, v20, v14 row_newbcast:2 row_mask:0xf bank_mask:0xf
    v_and_b32_dpp v35, v20, v15 row_newbcast:2 row_mask:0xf bank_mask:0xf
    v_and_b32_dpp v36, v20, v12 row_newbcast:6 row_mask:0xf bank_mask:0xf
    v_and_b32_dpp v37, v20, v13 row_newbcast:6 row_mask:0xf bank_mask:0xf
    v_and_b32_dpp v38, v20, v14 row_newbcast:6 row_mask:0xf bank_mask:0xf
    v_and_b32_dpp v39, v20, v15 row_newbcast:6 row_mask:0xf bank_mask:0xf
    v_and_b32_dpp v40, v20, v12 row_newbcast:10 row_mask:0xf bank_mask:0xf
    v_and_b32_dpp v41, v20, v13 row_newbcast:10 row_mask:0xf bank_mask:0xf
    v_and_b32_dpp v42, v20, v14 row_newbcast:10 row_mask:0xf bank_mask:0xf
    v_and_b32_dpp v43, v20, v15 row_newbcast:10 row_mask:0xf bank_mask:0xf
    v_and_b32_dpp v44, v20, v12 row_newbcast:14 row_mask:0xf bank_mask:0xf
    v_and_b32_dpp v45, v20, v13 row_newbcast:14 row_mask:0xf bank_mask:0xf
    v_and_b32_dpp v46, v20, v14 row_newbcast:14 row_mask:0xf bank_mask:0xf
    v_and_b32_dpp v47, v20, v15 row_newbcast:14 row_mask:0xf bank_mask:0xf
    s_waitcnt vmcnt(3)
    buffer_load_dwordx4 v[64:67], v2, s[28:31], s48 offen offset:0 nt
    s_waitcnt vmcnt(3)
    buffer_load_dwordx4 v[68:71], v5, s[28:31], s48 offen offset:0 nt
    s_waitcnt vmcnt(3)
    buffer_load_dwordx4 v[72:75], v2, s[28:31], s48 offen offset:2048 nt
    s_waitcnt vmcnt(3)
    buffer_load_dwordx4 v[76:79], v5, s[28:31], s48 offen offset:2048 nt
    s_add_u32 s48, s48, 0x8000
    v_mfma_f32_16x16x32_bf16 v[16:19], v[80:83], v[32:35], v[16:19]
    v_mfma_f32_16x16x32_bf16 v[16:19], v[84:87], v[36:39], v[16:19]
    v_mfma_f32_16x16x32_bf16 v[16:19], v[88:91], v[40:43], v[16:19]
    v_mfma_f32_16x16x32_bf16 v[16:19], v[92:95], v[44:47], v[16:19]
    v_and_b32_dpp v32, v20, v12 row_newbcast:3 row_mask:0xf bank_mask:0xf
    v_and_b32_dpp v33, v20, v13 row_newbcast:3 row_mask:0xf bank_mask:0xf
    v_and_b32_dpp v34, v20, v14 row_newbcast:3 row_mask:0xf bank_mask:0xf
    v_and_b32_dpp v35, v20, v15 row_newbcast:3 row_mask:0xf bank_mask:0xf
    v_and_b32_dpp v36, v20, v12 row_newbcast:7 row_mask:0xf bank_mask:0xf
    v_and_b32_dpp v37, v20, v13 row_newbcast:7 row_mask:0xf bank_mask:0xf
    v_and_b32_dpp v38, v20, v14 row_newbcast:7 row_mask:0xf bank_mask:0xf
    v_and_b32_dpp v39, v20, v15 row_newbcast:7 row_mask:0xf bank_mask:0xf
    v_and_b32_dpp v40, v20, v12 row_newbcast:11 row_mask:0xf bank_mask:0xf
    v_and_b32_dpp v41, v20, v13 row_newbcast:11 row_mask:0xf bank_mask:0xf
    v_and_b32_dpp v42, v20, v14 row_newbcast:11 row_mask:0xf bank_mask:0xf
    v_and_b32_dpp v43, v20, v15 row_newbcast:11 row_mask:0xf bank_mask:0xf
    v_and_b32_dpp v44, v20, v12 row_newbcast:15 row_mask:0xf bank_mask:0xf
    v_and_b32_dpp v45, v20, v13 row_newbcast:15 row_mask:0xf bank_mask:0xf
    v_and_b32_dpp v46, v20, v14 row_newbcast:15 row_mask:0xf bank_mask:0xf
    v_and_b32_dpp v47, v20, v15 row_newbcast:15 row_mask:0xf bank_mask:0xf
    s_waitcnt vmcnt(3)
    buffer_load_dwordx4 v[80:83], v2, s[28:31], s48 offen offset:0 nt
    s_waitcnt vmcnt(3)
    buffer_load_dwordx4 v[84:87], v5, s[28:31], s48 offen offset:0 nt
    s_waitcnt vmcnt(3)
    buffer_load_dwordx4 v[88:91], v2, s[28:31], s48 offen offset:2048 nt
    s_waitcnt vmcnt(3)
    buffer_load_dwordx4 v[92:95], v5, s[28:31], s48 offen offset:2048 nt
    s_add_u32 s48, s48, 0x8000
    v_mfma_f32_16x16x32_bf16 v[16:19], v[96:99], v[32:35], v[16:19]
    v_mfma_f32_16x16x32_bf16 v[16:19], v[100:103], v[36:39], v[16:19]
    v_mfma_f32_16x16x32_bf16 v[16:19], v[104:107], v[40:43], v[16:19]
    v_mfma_f32_16x16x32_bf16 v[16:19], v[108:111], v[44:47], v[16:19]
    v_mov_b32 v20, v21
    v_mov_b32 v21, v22
    v_mov_b32 v22, v23
    v_and_b32_dpp v32, v20, v12 row_newbcast:0 row_mask:0xf bank_mask:0xf
    v_and_b32_dpp v33, v20, v13 row_newbcast:0 row_mask:0xf bank_mask:0xf
    v_and_b32_dpp v34, v20, v14 row_newbcast:0 row_mask:0xf bank_mask:0xf
    v_and_b32_dpp v35, v20, v15 row_newbcast:0 row_mask:0xf bank_mask:0xf
    v_and_b32_dpp v36, v20, v12 row_newbcast:4 row_mask:0xf bank_mask:0xf
    v_and_b32_dpp v37, v20, v13 row_newbcast:4 row_mask:0xf bank_mask:0xf
    v_and_b32_dpp v38, v20, v14 row_newbcast:4 row_mask:0xf bank_mask:0xf
    v_and_b32_dpp v39, v20, v15 row_newbcast:4 row_mask:0xf bank_mask:0xf
    v_and_b32_dpp v40, v20, v12 row_newbcast:8 row_mask:0xf bank_mask:0xf
    v_and_b32_dpp v41, v20, v13 row_newbcast:8 row_mask:0xf bank_mask:0xf
    v_and_b32_dpp v42, v20, v14 row_newbcast:8 row_mask:0xf bank_mask:0xf
    v_and_b32_dpp v43, v20, v15 row_newbcast:8 row_mask:0xf bank_mask:0xf
    v_and_b32_dpp v44, v20, v12 row_newbcast:12 row_mask:0xf bank_mask:0xf
    v_and_b32_dpp v45, v20, v13 row_newbcast:12 row_mask:0xf bank_mask:0xf
    v_and_b32_dpp v46, v20, v14 row_newbcast:12 row_mask:0xf bank_mask:0xf
    v_and_b32_dpp v47, v20, v15 row_newbcast:12 row_mask:0xf bank_mask:0xf
    s_waitcnt vmcnt(3)
    buffer_load_dwordx4 v[96:99], v2, s[28:31], s48 offen offset:0 nt
    s_waitcnt vmcnt(3)
    buffer_load_dwordx4 v[100:103], v5, s[28:31], s48 offen offset:0 nt
    s_waitcnt vmcnt(3)
    buffer_load_dwordx4 v[104:107], v2, s[28:31], s48 offen offset:2048 nt
    s_waitcnt vmcnt(3)
    buffer_load_dwordx4 v[108:111], v5, s[28:31], s48 offen offset:2048 nt
    s_add_u32 s34, s34, 1
    s_and_b32 s48, s34, 1
    s_lshl_b32 s48, s48, 17
    s_bfe_u32 s35, s34, 0x10001
    s_lshl_b32 s35, s35, 18
    s_add_u32 s48, s48, s35
    s_add_u32 s48, s48, s93
    v_xor_b32 v2, 0x2000, v2
    v_xor_b32 v5, 0x2000, v5
    v_mfma_f32_16x16x32_bf16 v[16:19], v[48:51], v[32:35], v[16:19]
    v_mfma_f32_16x16x32_bf16 v[16:19], v[52:55], v[36:39], v[16:19]
    v_mfma_f32_16x16x32_bf16 v[16:19], v[56:59], v[40:43], v[16:19]
    v_mfma_f32_16x16x32_bf16 v[16:19], v[60:63], v[44:47], v[16:19]
    v_and_b32_dpp v32, v20, v12 row_newbcast:1 row_mask:0xf bank_mask:0xf
    v_and_b32_dpp v33, v20, v13 row_newbcast:1 row_mask:0xf bank_mask:0xf
    v_and_b32_dpp v34, v20, v14 row_newbcast:1 row_mask:0xf bank_mask:0xf
    v_and_b32_dpp v35, v20, v15 row_newbcast:1 row_mask:0xf bank_mask:0xf
    v_and_b32_dpp v36, v20, v12 row_newbcast:5 row_mask:0xf bank_mask:0xf
    v_and_b32_dpp v37, v20, v13 row_newbcast:5 row_mask:0xf bank_mask:0xf
    v_and_b32_dpp v38, v20, v14 row_newbcast:5 row_mask:0xf bank_mask:0xf
    v_and_b32_dpp v39, v20, v15 row_newbcast:5 row_mask:0xf bank_mask:0xf
    v_and_b32_dpp v40, v20, v12 row_newbcast:9 row_mask:0xf bank_mask:0xf
    v_and_b32_dpp v41, v20, v13 row_newbcast:9 row_mask:0xf bank_mask:0xf
    v_and_b32_dpp v42, v20, v14 row_newbcast:9 row_mask:0xf bank_mask:0xf
    v_and_b32_dpp v43, v20, v15 row_newbcast:9 row_mask:0xf bank_mask:0xf
    v_and_b32_dpp v44, v20, v12 row_newbcast:13 row_mask:0xf bank_mask:0xf
    v_and_b32_dpp v45, v20, v13 row_newbcast:13 row_mask:0xf bank_mask:0xf
    v_and_b32_dpp v46, v20, v14 row_newbcast:13 row_mask:0xf bank_mask:0xf
    v_and_b32_dpp v47, v20, v15 row_newbcast:13 row_mask:0xf bank_mask:0xf
    v_mfma_f32_16x16x32_bf16 v[16:19], v[64:67], v[32:35], v[16:19]
    v_mfma_f32_16x16x32_bf16 v[16:19], v[68:71], v[36:39], v[16:19]
    v_mfma_f32_16x16x32_bf16 v[16:19], v[72:75], v[40:43], v[16:19]
    v_mfma_f32_16x16x32_bf16 v[16:19], v[76:79], v[44:47], v[16:19]
    v_and_b32_dpp v32, v20, v12 row_newbcast:2 row_mask:0xf bank_mask:0xf
    v_and_b32_dpp v33, v20, v13 row_newbcast:2 row_mask:0xf bank_mask:0xf
    v_and_b32_dpp v34, v20, v14 row_newbcast:2 row_mask:0xf bank_mask:0xf
    v_and_b32_dpp v35, v20, v15 row_newbcast:2 row_mask:0xf bank_mask:0xf
    v_and_b32_dpp v36, v20, v12 row_newbcast:6 row_mask:0xf bank_mask:0xf
    v_and_b32_dpp v37, v20, v13 row_newbcast:6 row_mask:0xf bank_mask:0xf
    v_and_b32_dpp v38, v20, v14 row_newbcast:6 row_mask:0xf bank_mask:0xf
    v_and_b32_dpp v39, v20, v15 row_newbcast:6 row_mask:0xf bank_mask:0xf
    v_and_b32_dpp v40, v20, v12 row_newbcast:10 row_mask:0xf bank_mask:0xf
    v_and_b32_dpp v41, v20, v13 row_newbcast:10 row_mask:0xf bank_mask:0xf
    v_and_b32_dpp v42, v20, v14 row_newbcast:10 row_mask:0xf bank_mask:0xf
    v_and_b32_dpp v43, v20, v15 row_newbcast:10 row_mask:0xf bank_mask:0xf
    v_and_b32_dpp v44, v20, v12 row_newbcast:14 row_mask:0xf bank_mask:0xf
    v_and_b32_dpp v45, v20, v13 row_newbcast:14 row_mask:0xf bank_mask:0xf
    v_and_b32_dpp v46, v20, v14 row_newbcast:14 row_mask:0xf bank_mask:0xf
    v_and_b32_dpp v47, v20, v15 row_newbcast:14 row_mask:0xf bank_mask:0xf
    v_mfma_f32_16x16x32_bf16 v[16:19], v[80:83], v[32:35], v[16:19]
    v_mfma_f32_16x16x32_bf16 v[16:19], v[84:87], v[36:39], v[16:19]
    v_mfma_f32_16x16x32_bf16 v[16:19], v[88:91], v[40:43], v[16:19]
    v_mfma_f32_16x16x32_bf16 v[16:19], v[92:95], v[44:47], v[16:19]
    v_and_b32_dpp v32, v20, v12 row_newbcast:3 row_mask:0xf bank_mask:0xf
    v_and_b32_dpp v33, v20, v13 row_newbcast:3 row_mask:0xf bank_mask:0xf
    v_and_b32_dpp v34, v20, v14 row_newbcast:3 row_mask:0xf bank_mask:0xf
    v_and_b32_dpp v35, v20, v15 row_newbcast:3 row_mask:0xf bank_mask:0xf
    v_and_b32_dpp v36, v20, v12 row_newbcast:7 row_mask:0xf bank_mask:0xf
    v_and_b32_dpp v37, v20, v13 row_newbcast:7 row_mask:0xf bank_mask:0xf
    v_and_b32_dpp v38, v20, v14 row_newbcast:7 row_mask:0xf bank_mask:0xf
    v_and_b32_dpp v39, v20, v15 row_newbcast:7 row_mask:0xf bank_mask:0xf
    v_and_b32_dpp v40, v20, v12 row_newbcast:11 row_mask:0xf bank_mask:0xf
    v_and_b32_dpp v41, v20, v13 row_newbcast:11 row_mask:0xf bank_mask:0xf
    v_and_b32_dpp v42, v20, v14 row_newbcast:11 row_mask:0xf bank_mask:0xf
    v_and_b32_dpp v43, v20, v15 row_newbcast:11 row_mask:0xf bank_mask:0xf
    v_and_b32_dpp v44, v20, v12 row_newbcast:15 row_mask:0xf bank_mask:0xf
    v_and_b32_dpp v45, v20, v13 row_newbcast:15 row_mask:0xf bank_mask:0xf
    v_and_b32_dpp v46, v20, v14 row_newbcast:15 row_mask:0xf bank_mask:0xf
    v_and_b32_dpp v47, v20, v15 row_newbcast:15 row_mask:0xf bank_mask:0xf
    s_waitcnt vmcnt(3)
    v_mfma_f32_16x16x32_bf16 v[16:19], v[96:99], v[32:35], v[16:19]
    s_waitcnt vmcnt(2)
    v_mfma_f32_16x16x32_bf16 v[16:19], v[100:103], v[36:39], v[16:19]
    s_waitcnt vmcnt(1)
    v_mfma_f32_16x16x32_bf16 v[16:19], v[104:107], v[40:43], v[16:19]
    s_waitcnt vmcnt(0)
    v_mfma_f32_16x16x32_bf16 v[16:19], v[108:111], v[44:47], v[16:19]
    s_cmp_eq_u32 s60, 1
    s_nop 6
    ds_write_b128 v3, v[16:19]
    s_waitcnt lgkmcnt(0)
    s_barrier
    s_cbranch_scc1 L_s2
    s_cmp_eq_u32 s60, 2
    s_cbranch_scc1 L_s3
    s_endpgm
L_thrk0:
    s_waitcnt vmcnt(0)
    buffer_load_dwordx4 v[48:51], v2, s[28:31], s48 offen offset:0 nt
    s_waitcnt vmcnt(0)
    buffer_load_dwordx4 v[52:55], v5, s[28:31], s48 offen offset:0 nt
    s_waitcnt vmcnt(0)
    buffer_load_dwordx4 v[56:59], v2, s[28:31], s48 offen offset:2048 nt
    s_waitcnt vmcnt(0)
    buffer_load_dwordx4 v[60:63], v5, s[28:31], s48 offen offset:2048 nt
    s_add_u32 s48, s48, 0x8000
    s_branch L_thrbk0
L_thrk1:
    s_waitcnt vmcnt(0)
    buffer_load_dwordx4 v[64:67], v2, s[28:31], s48 offen offset:0 nt
    s_waitcnt vmcnt(0)
    buffer_load_dwordx4 v[68:71], v5, s[28:31], s48 offen offset:0 nt
    s_waitcnt vmcnt(0)
    buffer_load_dwordx4 v[72:75], v2, s[28:31], s48 offen offset:2048 nt
    s_waitcnt vmcnt(0)
    buffer_load_dwordx4 v[76:79], v5, s[28:31], s48 offen offset:2048 nt
    s_add_u32 s48, s48, 0x8000
    s_branch L_thrbk1
L_thrk2:
    s_waitcnt vmcnt(0)
    buffer_load_dwordx4 v[80:83], v2, s[28:31], s48 offen offset:0 nt
    s_waitcnt vmcnt(0)
    buffer_load_dwordx4 v[84:87], v5, s[28:31], s48 offen offset:0 nt
    s_waitcnt vmcnt(0)
    buffer_load_dwordx4 v[88:91], v2, s[28:31], s48 offen offset:2048 nt
    s_waitcnt vmcnt(0)
    buffer_load_dwordx4 v[92:95], v5, s[28:31], s48 offen offset:2048 nt
    s_add_u32 s48, s48, 0x8000
    s_branch L_thrbk2
L_thrk3:
    s_waitcnt vmcnt(0)
    buffer_load_dwordx4 v[96:99], v2, s[28:31], s48 offen offset:0 nt
    s_waitcnt vmcnt(0)
    buffer_load_dwordx4 v[100:103], v5, s[28:31], s48 offen offset:0 nt
    s_waitcnt vmcnt(0)
    buffer_load_dwordx4 v[104:107], v2, s[28:31], s48 offen offset:2048 nt
    s_waitcnt vmcnt(0)
    buffer_load_dwordx4 v[108:111], v5, s[28:31], s48 offen offset:2048 nt
    s_add_u32 s34, s34, 1
    s_and_b32 s48, s34, 1
    s_lshl_b32 s48, s48, 17
    s_bfe_u32 s35, s34, 0x10001
    s_lshl_b32 s35, s35, 18
    s_add_u32 s48, s48, s35
    s_add_u32 s48, s48, s93
    v_xor_b32 v2, 0x2000, v2
    v_xor_b32 v5, 0x2000, v5
    s_branch L_thrbk3
L_thrv0:
    s_waitcnt vmcnt(0)
    buffer_load_dwordx4 v[48:51], v2, s[28:31], s48 offen offset:0 nt
    s_waitcnt vmcnt(0)
    buffer_load_dwordx4 v[52:55], v5, s[28:31], s48 offen offset:0 nt
    s_waitcnt vmcnt(0)
    buffer_load_dwordx4 v[56:59], v2, s[28:31], s48 offen offset:2048 nt
    s_waitcnt vmcnt(0)
    buffer_load_dwordx4 v[60:63], v5, s[28:31], s48 offen offset:2048 nt
    s_add_u32 s48, s48, 0x8000
    s_branch L_thrbv0
L_thrv1:
    s_waitcnt vmcnt(0)
    buffer_load_dwordx4 v[64:67], v2, s[28:31], s48 offen offset:0 nt
    s_waitcnt vmcnt(0)
    buffer_load_dwordx4 v[68:71], v5, s[28:31], s48 offen offset:0 nt
    s_waitcnt vmcnt(0)
    buffer_load_dwordx4 v[72:75], v2, s[28:31], s48 offen offset:2048 nt
    s_waitcnt vmcnt(0)
    buffer_load_dwordx4 v[76:79], v5, s[28:31], s48 offen offset:2048 nt
    s_add_u32 s48, s48, 0x8000
    s_branch L_thrbv1
L_thrv2:
    s_waitcnt vmcnt(0)
    buffer_load_dwordx4 v[80:83], v2, s[28:31], s48 offen offset:0 nt
    s_waitcnt vmcnt(0)
    buffer_load_dwordx4 v[84:87], v5, s[28:31], s48 offen offset:0 nt
    s_waitcnt vmcnt(0)
    buffer_load_dwordx4 v[88:91], v2, s[28:31], s48 offen offset:2048 nt
    s_waitcnt vmcnt(0)
    buffer_load_dwordx4 v[92:95], v5, s[28:31], s48 offen offset:2048 nt
    s_add_u32 s48, s48, 0x8000
    s_branch L_thrbv2
L_thrv3:
    s_waitcnt vmcnt(0)
    buffer_load_dwordx4 v[96:99], v2, s[28:31], s48 offen offset:0 nt
    s_waitcnt vmcnt(0)
    buffer_load_dwordx4 v[100:103], v5, s[28:31], s48 offen offset:0 nt
    s_waitcnt vmcnt(0)
    buffer_load_dwordx4 v[104:107], v2, s[28:31], s48 offen offset:2048 nt
    s_waitcnt vmcnt(0)
    buffer_load_dwordx4 v[108:111], v5, s[28:31], s48 offen offset:2048 nt
    s_add_u32 s34, s34, 1
    s_and_b32 s48, s34, 1
    s_lshl_b32 s48, s48, 17
    s_bfe_u32 s35, s34, 0x10001
    s_lshl_b32 s35, s35, 18
    s_add_u32 s48, s48, s35
    s_add_u32 s48, s48, s93
    v_xor_b32 v2, 0x2000, v2
    v_xor_b32 v5, 0x2000, v5
    s_branch L_thrbv3
L_kdma0:
    s_mov_b32 s49, s54
    s_mov_b32 m0, s55
    s_waitcnt vmcnt(2)
    buffer_load_dwordx4 v120, s[40:43], s49 offen nt lds
    s_add_u32 s49, s54, s88
    s_add_u32 m0, s55, s91
    s_waitcnt vmcnt(2)
    buffer_load_dwordx4 v120, s[40:43], s49 offen nt lds
    s_add_u32 s49, s54, s89
    s_add_u32 m0, s55, s94
    s_waitcnt vmcnt(2)
    buffer_load_dwordx4 v120, s[40:43], s49 offen nt lds
    s_add_u32 s49, s49, s88
    s_add_u32 m0, m0, s91
    s_waitcnt vmcnt(2)
    buffer_load_dwordx4 v120, s[40:43], s49 offen nt lds
    s_add_u32 s54, s54, s90
    s_add_u32 s55, s55, s95
    s_add_u32 s48, s48, 0x8000
    s_branch L_thrbk0
L_kdma1:
    s_mov_b32 s49, s54
    s_mov_b32 m0, s55
    s_waitcnt vmcnt(2)
    buffer_load_dwordx4 v120, s[40:43], s49 offen nt lds
    s_add_u32 s49, s54, s88
    s_add_u32 m0, s55, s91
    s_waitcnt vmcnt(2)
    buffer_load_dwordx4 v120, s[40:43], s49 offen nt lds
    s_add_u32 s49, s54, s89
    s_add_u32 m0, s55, s94
    s_waitcnt vmcnt(2)
    buffer_load_dwordx4 v120, s[40:43], s49 offen nt lds
    s_add_u32 s49, s49, s88
    s_add_u32 m0, m0, s91
    s_waitcnt vmcnt(2)
    buffer_load_dwordx4 v120, s[40:43], s49 offen nt lds
    s_add_u32 s54, s54, s90
    s_add_u32 s55, s55, s95
    s_add_u32 s48, s48, 0x8000
    s_branch L_thrbk1
L_s2:
    v_bfe_u32 v23, v1, 2, 2
    v_and_b32 v24, 3, v1
    v_lshlrev_b32 v24, 3, v24
    v_lshrrev_b32 v22, 4, v1
    s_lshl_b32 s48, s3, 14
    v_lshl_add_u32 v25, v22, 11, v24
    v_lshl_add_u32 v25, v23, 8, v25
    v_add_u32 v25, s48, v25
    v_xor_b32 v26, 0, v23
    v_lshl_add_u32 v28, v26, 5, v25
    v_xor_b32 v26, 1, v23
    v_lshl_add_u32 v29, v26, 5, v25
    v_xor_b32 v26, 2, v23
    v_lshl_add_u32 v30, v26, 5, v25
    v_xor_b32 v26, 3, v23
    v_lshl_add_u32 v31, v26, 5, v25
    ds_read_b64_tr_b16 v[48:49], v28 offset:0
    ds_read_b64_tr_b16 v[50:51], v28 offset:1024
    ds_read_b64_tr_b16 v[64:65], v29 offset:0
    ds_read_b64_tr_b16 v[66:67], v29 offset:1024
    ds_read_b64_tr_b16 v[80:81], v30 offset:0
    ds_read_b64_tr_b16 v[82:83], v30 offset:1024
    ds_read_b64_tr_b16 v[96:97], v31 offset:0
    ds_read_b64_tr_b16 v[98:99], v31 offset:1024
    ds_read_b64_tr_b16 v[52:53], v28 offset:8192
    ds_read_b64_tr_b16 v[54:55], v28 offset:9216
    ds_read_b64_tr_b16 v[68:69], v29 offset:8192
    ds_read_b64_tr_b16 v[70:71], v29 offset:9216
    ds_read_b64_tr_b16 v[84:85], v30 offset:8192
    ds_read_b64_tr_b16 v[86:87], v30 offset:9216
    ds_read_b64_tr_b16 v[100:101], v31 offset:8192
    ds_read_b64_tr_b16 v[102:103], v31 offset:9216
    ds_read_b64_tr_b16 v[56:57], v28 offset:128
    ds_read_b64_tr_b16 v[58:59], v28 offset:1152
    ds_read_b64_tr_b16 v[72:73], v29 offset:128
    ds_read_b64_tr_b16 v[74:75], v29 offset:1152
    ds_read_b64_tr_b16 v[88:89], v30 offset:128
    ds_read_b64_tr_b16 v[90:91], v30 offset:1152
    ds_read_b64_tr_b16 v[104:105], v31 offset:128
    ds_read_b64_tr_b16 v[106:107], v31 offset:1152
    ds_read_b64_tr_b16 v[60:61], v28 offset:8320
    ds_read_b64_tr_b16 v[62:63], v28 offset:9344
    ds_read_b64_tr_b16 v[76:77], v29 offset:8320
    ds_read_b64_tr_b16 v[78:79], v29 offset:9344
    ds_read_b64_tr_b16 v[92:93], v30 offset:8320
    ds_read_b64_tr_b16 v[94:95], v30 offset:9344
    ds_read_b64_tr_b16 v[108:109], v31 offset:8320
    ds_read_b64_tr_b16 v[110:111], v31 offset:9344
    v_mov_b32 v10, 0x4444
    v_mov_b32 v26, 0xeeee
    s_nop 1
    v_mov_b32_dpp v10, v26 quad_perm:[0,1,2,3] row_mask:0xf bank_mask:0xc
    v_mov_b32 v32, 0
    v_mov_b32 v33, 0
    v_mov_b32 v34, 0
    v_mov_b32 v35, 0
    v_mov_b32 v36, 0
    v_mov_b32 v37, 0
    v_mov_b32 v38, 0
    v_mov_b32 v39, 0
    v_mov_b32 v40, 0
    v_mov_b32 v41, 0
    v_mov_b32 v42, 0
    v_mov_b32 v43, 0
    v_mov_b32 v44, 0
    v_mov_b32 v45, 0
    v_mov_b32 v46, 0
    v_mov_b32 v47, 0
    s_and_b32 s49, s26, 0x18
    s_add_u32 s49, s49, s3
    v_lshlrev_b32 v22, 4, v1
    s_lshl_b32 s48, s49, 11
    s_add_u32 s48, s48, 65536
    v_lshlrev_b32 v27, 2, v0
    v_add_u32 v27, 135168, v27
    v_and_b32 v12, 0x3f803f80, v12
    v_and_b32 v13, 0x3f803f80, v13
    v_and_b32 v14, 0x3f803f80, v14
    v_and_b32 v15, 0x3f803f80, v15
    s_mov_b32 s51, 0
L_s2poll:
    s_sub_u32 s62, s62, 1
    s_cmp_lt_i32 s62, 0
    s_cbranch_scc1 L_s2pollgo
    buffer_load_dwordx4 v[112:115], v22, s[36:39], s48 offen offset:0 sc1
    buffer_load_dwordx4 v[116:119], v22, s[36:39], s48 offen offset:1024 sc1
    s_waitcnt vmcnt(0)
    v_max3_u32 v24, v112, v113, v114
    v_max3_u32 v25, v115, v116, v117
    v_max3_u32 v24, v24, v118, v119
    v_max_u32 v24, v24, v25
    v_cmp_eq_u32 vcc, -1, v24
    s_mov_b64 exec, vcc
    s_cbranch_vccnz L_s2poll
L_s2pollgo:
    s_mov_b64 exec, -1
    v_mfma_f32_16x16x32_bf16 v[16:19], v[112:115], v[12:15], 0
    v_mfma_f32_16x16x32_bf16 v[16:19], v[116:119], v[12:15], v[16:19]
    s_waitcnt lgkmcnt(0)
    s_nop 6
    v_cvt_pk_bf16_f32 v16, v16, v17
    v_cvt_pk_bf16_f32 v17, v18, v19
    s_nop 0
    v_mov_b32_dpp v120, v16 row_newbcast:0 row_mask:0xf bank_mask:0x3
    v_mov_b32_dpp v121, v16 row_newbcast:1 row_mask:0xf bank_mask:0x3
    v_mov_b32_dpp v122, v16 row_newbcast:2 row_mask:0xf bank_mask:0x3
    v_mov_b32_dpp v123, v16 row_newbcast:3 row_mask:0xf bank_mask:0x3
    v_mov_b32_dpp v120, v17 row_newbcast:0 row_mask:0xf bank_mask:0xc
    v_mov_b32_dpp v121, v17 row_newbcast:1 row_mask:0xf bank_mask:0xc
    v_mov_b32_dpp v122, v17 row_newbcast:2 row_mask:0xf bank_mask:0xc
    v_mov_b32_dpp v123, v17 row_newbcast:3 row_mask:0xf bank_mask:0xc
    v_mov_b32_dpp v124, v16 row_newbcast:4 row_mask:0xf bank_mask:0x3
    v_mov_b32_dpp v124, v17 row_newbcast:4 row_mask:0xf bank_mask:0xc
    v_smfmac_f32_16x16x64_bf16 v[32:35], v[120:123], v[48:55], v10
    v_mov_b32_dpp v125, v16 row_newbcast:5 row_mask:0xf bank_mask:0x3
    v_mov_b32_dpp v125, v17 row_newbcast:5 row_mask:0xf bank_mask:0xc
    v_smfmac_f32_16x16x64_bf16 v[36:39], v[120:123], v[64:71], v10
    v_mov_b32_dpp v126, v16 row_newbcast:6 row_mask:0xf bank_mask:0x3
    v_mov_b32_dpp v126, v17 row_newbcast:6 row_mask:0xf bank_mask:0xc
    v_smfmac_f32_16x16x64_bf16 v[40:43], v[120:123], v[80:87], v10
    v_mov_b32_dpp v127, v16 row_newbcast:7 row_mask:0xf bank_mask:0x3
    v_mov_b32_dpp v127, v17 row_newbcast:7 row_mask:0xf bank_mask:0xc
    v_smfmac_f32_16x16x64_bf16 v[44:47], v[120:123], v[96:103], v10
    s_nop 0
    v_smfmac_f32_16x16x64_bf16 v[32:35], v[124:127], v[56:63], v10
    v_smfmac_f32_16x16x64_bf16 v[36:39], v[124:127], v[72:79], v10
    v_smfmac_f32_16x16x64_bf16 v[40:43], v[124:127], v[88:95], v10
    v_smfmac_f32_16x16x64_bf16 v[44:47], v[124:127], v[104:111], v10
    s_nop 6
    v_permlane32_swap_b32 v32, v40
    v_permlane32_swap_b32 v36, v44
    v_add_f32 v36, v36, v44
    v_add_f32 v32, v32, v40
    s_nop 0
    v_mov_b32_dpp v32, v36 quad_perm:[0,1,2,3] row_mask:0xa bank_mask:0xf
    ds_write_b32 v27, v32
    s_cmp_eq_u32 s3, 8
    s_cbranch_scc1 L_s2back
    s_waitcnt lgkmcnt(0)
    s_barrier
    s_endpgm
L_s3:
    s_mov_b32 s44, s4
    s_mov_b32 s45, s5
    s_mov_b32 s46, 1024
    s_mov_b32 s47, 0x20000
    ds_read_b32 v15, v4 offset:48
    ds_read_b32 v90, v4 offset:52
    v_lshrrev_b32 v25, 4, v1
    v_and_b32 v26, 1, v25
    v_lshlrev_b32 v26, 1, v26
    v_lshrrev_b32 v27, 1, v25
    v_or_b32 v26, v26, v27
    v_and_b32 v27, 15, v1
    v_lshl_add_u32 v26, v27, 2, v26
    s_lshl_b32 s48, s3, 6
    v_add_u32 v28, s48, v26
    v_lshlrev_b32 v28, 1, v28
    buffer_load_ushort v6, v28, s[44:47], 0 offen
    v_add_u32 v8, 133632, v28
    v_lshlrev_b32 v7, 11, v25
    v_lshl_add_u32 v7, v27, 4, v7
    s_lshl_b32 s50, s3, 8
    s_add_u32 s50, s50, 262144
    v_lshlrev_b32 v10, 4, v1
    v_add_u32 v10, 135168, v10
    s_lshr_b32 s48, s3, 2
    s_lshl_b32 s48, s48, 10
    s_and_b32 s49, s3, 3
    s_lshl_b32 s49, s49, 2
    s_add_u32 s48, s48, s49
    v_add_u32 v9, s48, v10
    v_and_b32 v11, 7, v1
    v_lshlrev_b32 v11, 3, v11
    v_add_u32 v11, 137216, v11
    s_lshl_b32 s48, s3, 3
    s_add_u32 s48, s48, 137216
    v_mov_b32 v12, s48
    v_lshlrev_b32 v13, 2, v1
    s_lshl_b32 s49, s26, 11
    s_lshl_b32 s48, s3, 8
    s_add_u32 s49, s49, s48
    s_add_u32 s49, s49, 278528
    v_bfe_u32 v22, v1, 2, 2
    v_and_b32 v24, 3, v1
    v_lshlrev_b32 v24, 3, v24
    v_lshl_add_u32 v23, v25, 3, v22
    v_mul_u32_u24 v23, 1056, v23
    v_add_u32 v23, v23, v24
    s_lshl_b32 s48, s3, 7
    s_add_u32 s48, s48, 65536
    v_add_u32 v23, s48, v23
    ds_read_b64_tr_b16 v[112:113], v23 offset:0
    ds_read_b64_tr_b16 v[114:115], v23 offset:4224
    ds_read_b64_tr_b16 v[116:117], v23 offset:33792
    ds_read_b64_tr_b16 v[118:119], v23 offset:38016
    ds_read_b64_tr_b16 v[120:121], v23 offset:32
    ds_read_b64_tr_b16 v[122:123], v23 offset:4256
    ds_read_b64_tr_b16 v[124:125], v23 offset:33824
    ds_read_b64_tr_b16 v[126:127], v23 offset:38048
    ds_read_b64_tr_b16 v[128:129], v23 offset:64
    ds_read_b64_tr_b16 v[130:131], v23 offset:4288
    ds_read_b64_tr_b16 v[132:133], v23 offset:33856
    ds_read_b64_tr_b16 v[134:135], v23 offset:38080
    ds_read_b64_tr_b16 v[136:137], v23 offset:96
    ds_read_b64_tr_b16 v[138:139], v23 offset:4320
    ds_read_b64_tr_b16 v[140:141], v23 offset:33888
    ds_read_b64_tr_b16 v[142:143], v23 offset:38112
    v_lshrrev_b32 v26, 5, v1
    v_lshlrev_b32 v26, 1, v26
    v_lshl_add_u32 v23, v22, 2, v26
    v_bfe_u32 v29, v23, 1, 2
    v_and_b32 v26, 1, v25
    v_lshl_add_u32 v23, v26, 5, v23
    v_lshl_add_u32 v23, v23, 7, v24
    s_lshl_b32 s48, s3, 13
    v_add_u32 v23, s48, v23
    v_xor_b32 v30, 0, v29
    v_lshl_add_u32 v30, v30, 5, v23
    ds_read_b64_tr_b16 v[48:49], v30 offset:0
    ds_read_b64_tr_b16 v[50:51], v30 offset:2048
    ds_read_b64_tr_b16 v[52:53], v30 offset:128
    ds_read_b64_tr_b16 v[54:55], v30 offset:2176
    v_xor_b32 v30, 1, v29
    v_lshl_add_u32 v30, v30, 5, v23
    ds_read_b64_tr_b16 v[56:57], v30 offset:0
    ds_read_b64_tr_b16 v[58:59], v30 offset:2048
    ds_read_b64_tr_b16 v[60:61], v30 offset:128
    ds_read_b64_tr_b16 v[62:63], v30 offset:2176
    v_xor_b32 v30, 2, v29
    v_lshl_add_u32 v30, v30, 5, v23
    ds_read_b64_tr_b16 v[64:65], v30 offset:0
    ds_read_b64_tr_b16 v[66:67], v30 offset:2048
    ds_read_b64_tr_b16 v[68:69], v30 offset:128
    ds_read_b64_tr_b16 v[70:71], v30 offset:2176
    v_xor_b32 v30, 3, v29
    v_lshl_add_u32 v30, v30, 5, v23
    ds_read_b64_tr_b16 v[72:73], v30 offset:0
    ds_read_b64_tr_b16 v[74:75], v30 offset:2048
    ds_read_b64_tr_b16 v[76:77], v30 offset:128
    ds_read_b64_tr_b16 v[78:79], v30 offset:2176
    v_mov_b32 v91, 0x4444
    v_mov_b32 v26, 0xeeee
    s_nop 1
    v_mov_b32_dpp v91, v26 quad_perm:[0,1,2,3] row_mask:0xf bank_mask:0xc
    v_mov_b32 v32, 0
    v_mov_b32 v96, 0
    v_mov_b32 v33, 0
    v_mov_b32 v97, 0
    v_mov_b32 v34, 0
    v_mov_b32 v98, 0
    v_mov_b32 v35, 0
    v_mov_b32 v99, 0
    v_mov_b32 v36, 0
    v_mov_b32 v100, 0
    v_mov_b32 v37, 0
    v_mov_b32 v101, 0
    v_mov_b32 v38, 0
    v_mov_b32 v102, 0
    v_mov_b32 v39, 0
    v_mov_b32 v103, 0
    v_mov_b32 v40, 0
    v_mov_b32 v104, 0
    v_mov_b32 v41, 0
    v_mov_b32 v105, 0
    v_mov_b32 v42, 0
    v_mov_b32 v106, 0
    v_mov_b32 v43, 0
    v_mov_b32 v107, 0
    v_mov_b32 v44, 0
    v_mov_b32 v108, 0
    v_mov_b32 v45, 0
    v_mov_b32 v109, 0
    v_mov_b32 v46, 0
    v_mov_b32 v110, 0
    v_mov_b32 v47, 0
    v_mov_b32 v111, 0
    v_mov_b32 v16, 1.0
    v_mov_b32 v89, v13
    v_mov_b32 v13, 0x7ff00000
    s_mov_b32 s51, 1
    s_waitcnt vmcnt(0) lgkmcnt(0)
    v_lshlrev_b32 v6, 16, v6
    v_readfirstlane_b32 s52, v90
    s_branch L_s3pack
L_s3real:
    v_mov_b32 v14, v88
    v_mov_b32 v13, v89
    s_mov_b32 s51, 0
    v_mov_b32 v32, 0
    v_mov_b32 v96, 0
    v_mov_b32 v33, 0
    v_mov_b32 v97, 0
    v_mov_b32 v34, 0
    v_mov_b32 v98, 0
    v_mov_b32 v35, 0
    v_mov_b32 v99, 0
    v_mov_b32 v36, 0
    v_mov_b32 v100, 0
    v_mov_b32 v37, 0
    v_mov_b32 v101, 0
    v_mov_b32 v38, 0
    v_mov_b32 v102, 0
    v_mov_b32 v39, 0
    v_mov_b32 v103, 0
    v_mov_b32 v40, 0
    v_mov_b32 v104, 0
    v_mov_b32 v41, 0
    v_mov_b32 v105, 0
    v_mov_b32 v42, 0
    v_mov_b32 v106, 0
    v_mov_b32 v43, 0
    v_mov_b32 v107, 0
    v_mov_b32 v44, 0
    v_mov_b32 v108, 0
    v_mov_b32 v45, 0
    v_mov_b32 v109, 0
    v_mov_b32 v46, 0
    v_mov_b32 v110, 0
    v_mov_b32 v47, 0
    v_mov_b32 v111, 0
    s_barrier
L_s3poll:
    s_sub_u32 s62, s62, 1
    s_cmp_lt_i32 s62, 0
    s_cbranch_scc1 L_s3pollgo
    buffer_load_dwordx4 v[20:23], v7, s[36:39], s50 offen sc1
    s_waitcnt vmcnt(0)
    v_xor_b32 v20, v20, v15
    v_xor_b32 v21, v21, v15
    v_xor_b32 v22, v22, v15
    v_xor_b32 v23, v23, v15
    v_or3_b32 v24, v20, v21, v22
    v_bitop3_b32 v24, v24, v23, s63 bitop3:0xa8
    v_cmp_ne_u32 vcc, 0, v24
    s_mov_b64 exec, vcc
    s_cbranch_vccnz L_s3poll
L_s3pollgo:
    s_mov_b64 exec, -1
    v_permlane32_swap_b32 v20, v21
    v_permlane32_swap_b32 v22, v23
    v_add_f32 v20, v20, v21
    v_add_f32 v22, v22, v23
    s_nop 1
    v_permlane16_swap_b32 v20, v22
    v_add_f32 v16, v20, v22
    v_cvt_pk_bf16_f32 v16, v16, v16
    v_lshlrev_b32 v16, 16, v16
    v_add_f32 v16, v16, v6
L_s3pack:
    s_nop 1
    v_mov_b32_dpp v17, v16 quad_perm:[1,0,3,2] row_mask:0xf bank_mask:0xf
    v_cvt_pk_bf16_f32 v17, v16, v17
    v_lshlrev_b32 v18, 16, v17
    v_mul_f32 v19, v18, v18
    v_mov_b32_dpp v24, v17 row_newbcast:0 row_mask:0xf bank_mask:0x3
    v_mov_b32_dpp v25, v17 row_newbcast:4 row_mask:0xf bank_mask:0x3
    v_mov_b32_dpp v26, v17 row_newbcast:8 row_mask:0xf bank_mask:0x3
    v_mov_b32_dpp v27, v17 row_newbcast:12 row_mask:0xf bank_mask:0x3
    v_mov_b32_dpp v24, v17 row_newbcast:2 row_mask:0xf bank_mask:0xc
    v_mov_b32_dpp v25, v17 row_newbcast:6 row_mask:0xf bank_mask:0xc
    v_mov_b32_dpp v26, v17 row_newbcast:10 row_mask:0xf bank_mask:0xc
    v_mov_b32_dpp v27, v17 row_newbcast:14 row_mask:0xf bank_mask:0xc
    v_add_f32_dpp v18, v18, v18 quad_perm:[1,0,3,2] row_mask:0xf bank_mask:0xf
    v_add_f32_dpp v19, v19, v19 quad_perm:[1,0,3,2] row_mask:0xf bank_mask:0xf
    v_smfmac_f32_16x16x64_bf16 v[32:35], v[24:27], v[48:55], v91
    v_add_f32_dpp v18, v18, v18 quad_perm:[2,3,0,1] row_mask:0xf bank_mask:0xf
    v_add_f32_dpp v19, v19, v19 quad_perm:[2,3,0,1] row_mask:0xf bank_mask:0xf
    v_smfmac_f32_16x16x64_bf16 v[36:39], v[24:27], v[56:63], v91
    v_add_f32_dpp v18, v18, v18 row_half_mirror row_mask:0xf bank_mask:0xf
    v_add_f32_dpp v19, v19, v19 row_half_mirror row_mask:0xf bank_mask:0xf
    v_smfmac_f32_16x16x64_bf16 v[40:43], v[24:27], v[64:71], v91
    v_add_f32_dpp v18, v18, v18 row_mirror row_mask:0xf bank_mask:0xf
    v_add_f32_dpp v19, v19, v19 row_mirror row_mask:0xf bank_mask:0xf
    v_smfmac_f32_16x16x64_bf16 v[44:47], v[24:27], v[72:79], v91
    v_add_f32_dpp v18, v18, v18 row_bcast:15 row_mask:0xa bank_mask:0xf
    v_add_f32_dpp v19, v19, v19 row_bcast:15 row_mask:0xa bank_mask:0xf
    ds_write_b16 v8, v17
    v_add_f32_dpp v18, v18, v18 row_bcast:31 row_mask:0xc bank_mask:0xf
    v_add_f32_dpp v19, v19, v19 row_bcast:31 row_mask:0xc bank_mask:0xf
    s_mov_b32 exec_lo, 0x0
    s_mov_b32 exec_hi, 0x80000000
    ds_write_b64 v12, v[18:19]
    s_mov_b64 exec, -1
    v_permlane32_swap_b32 v32, v40
    v_permlane32_swap_b32 v36, v44
    v_add_f32 v36, v36, v44
    v_add_f32 v32, v32, v40
    s_nop 0
    v_mov_b32_dpp v32, v36 quad_perm:[0,1,2,3] row_mask:0xa bank_mask:0xf
    ds_write_b32 v9, v32
    s_waitcnt lgkmcnt(0)
    s_barrier
    ds_read_b64 v[18:19], v11
    ds_read_b128 v[80:83], v10
    ds_read_b128 v[84:87], v10 offset:1024
    s_waitcnt lgkmcnt(2)
    v_add_f32_dpp v18, v18, v18 quad_perm:[1,0,3,2] row_mask:0xf bank_mask:0xf
    v_add_f32_dpp v19, v19, v19 quad_perm:[1,0,3,2] row_mask:0xf bank_mask:0xf
    s_waitcnt lgkmcnt(1)
    v_add_f32 v80, v80, v81
    v_add_f32_dpp v18, v18, v18 quad_perm:[2,3,0,1] row_mask:0xf bank_mask:0xf
    v_add_f32_dpp v19, v19, v19 quad_perm:[2,3,0,1] row_mask:0xf bank_mask:0xf
    v_add_f32 v82, v82, v83
    v_add_f32_dpp v18, v18, v18 row_half_mirror row_mask:0xf bank_mask:0xf
    v_add_f32_dpp v19, v19, v19 row_half_mirror row_mask:0xf bank_mask:0xf
    v_mul_f32 v18, 0x3b000000, v18
    v_mul_f32 v19, 0x3b000000, v19
    v_fma_f32 v19, -v18, v18, v19
    v_max_f32 v19, 0, v19
    v_cvt_pk_bf16_f32 v18, v19, v18
    v_lshlrev_b32 v19, 16, v18
    v_add_f32 v19, 0x3727c5ac, v19
    v_cvt_pk_bf16_f32 v19, v19, v19
    v_lshlrev_b32 v19, 16, v19
    v_sqrt_f32 v19, v19
    s_waitcnt lgkmcnt(0)
    v_add_f32 v84, v84, v85
    v_add_f32 v86, v86, v87
    v_cvt_pk_bf16_f32 v19, v19, v19
    v_lshlrev_b32 v19, 16, v19
    v_rcp_f32 v19, v19
    v_add_f32 v80, v80, v82
    v_add_f32 v84, v84, v86
    v_and_b32 v18, 0xffff0000, v18
    v_add_f32 v88, v80, v84
    v_fma_f32 v20, -v18, v14, v88
    v_mul_f32 v20, v20, v19
    v_cvt_pk_bf16_f32 v20, v20, v20
    v_lshlrev_b32 v20, 16, v20
    v_mul_f32 v21, 0xbfb8aa3b, v20
    v_exp_f32 v21, v21
    s_nop 0
    v_add_f32 v21, 1.0, v21
    v_rcp_f32 v21, v21
    s_nop 0
    v_mul_f32 v20, v20, v21
    s_nop 1
    v_mov_b32_dpp v17, v20 quad_perm:[1,0,3,2] row_mask:0xf bank_mask:0xf
    v_cvt_pk_bf16_f32 v17, v20, v17
    s_nop 1
    v_mov_b32_dpp v24, v17 row_newbcast:0 row_mask:0xf bank_mask:0x3
    v_mov_b32_dpp v25, v17 row_newbcast:4 row_mask:0xf bank_mask:0x3
    v_mov_b32_dpp v26, v17 row_newbcast:8 row_mask:0xf bank_mask:0x3
    v_mov_b32_dpp v27, v17 row_newbcast:12 row_mask:0xf bank_mask:0x3
    v_mov_b32_dpp v24, v17 row_newbcast:2 row_mask:0xf bank_mask:0xc
    v_mov_b32_dpp v25, v17 row_newbcast:6 row_mask:0xf bank_mask:0xc
    v_mov_b32_dpp v26, v17 row_newbcast:10 row_mask:0xf bank_mask:0xc
    v_mov_b32_dpp v27, v17 row_newbcast:14 row_mask:0xf bank_mask:0xc
    s_nop 1
    v_smfmac_f32_16x16x64_bf16 v[96:99], v[24:27], v[112:119], v91
    v_smfmac_f32_16x16x64_bf16 v[100:103], v[24:27], v[120:127], v91
    v_smfmac_f32_16x16x64_bf16 v[104:107], v[24:27], v[128:135], v91
    v_smfmac_f32_16x16x64_bf16 v[108:111], v[24:27], v[136:143], v91
    s_cmp_eq_u32 s52, 0
    s_nop 5
    v_permlane32_swap_b32 v96, v104
    v_permlane32_swap_b32 v100, v108
    v_add_f32 v100, v100, v108
    v_add_f32 v96, v96, v104
    s_nop 0
    v_mov_b32_dpp v96, v100 quad_perm:[0,1,2,3] row_mask:0xa bank_mask:0xf
    v_bfi_b32 v96, s63, v15, v96
    s_cbranch_scc1 L_zfar
    buffer_store_dword v96, v13, s[36:39], s49 offen
    s_branch L_zdone
L_zfar:
    buffer_store_dword v96, v13, s[36:39], s49 offen sc1
L_zdone:
    s_mov_b64 exec, -1
    s_cmp_lg_u32 s51, 0
    s_cbranch_scc1 L_s3real
    s_endpgm
L_service:
    v_lshrrev_b32 v2, 4, v1
    v_and_b32 v3, 15, v1
    v_lshlrev_b32 v4, 17, v2
    v_lshl_add_u32 v4, v3, 4, v4
    v_lshlrev_b32 v5, 4, v1
    v_mov_b32 v6, 0
    v_lshlrev_b32 v7, 1, v1
    s_lshl_b32 s48, s27, 19
    s_lshl_b32 s49, s26, 8
    s_add_u32 s48, s48, s49
    s_lshl_b32 s50, s27, 7
    s_mov_b32 s42, 4194304
    s_mov_b32 s43, 0x20000
    s_mov_b32 s46, 1024
    s_mov_b32 s47, 0x20000
    s_mov_b32 s38, 2097152
    s_mov_b32 s39, 0x20000
    s_waitcnt lgkmcnt(0)
    s_mov_b32 s44, s4
    s_mov_b32 s45, s5
    s_mov_b32 s40, s10
    s_mov_b32 s41, s11
    buffer_load_dwordx4 v[8:11], v5, s[44:47], 0 offen
    buffer_load_ushort v16, v7, s[44:47], s50 offen
    buffer_load_dwordx4 v[48:51], v4, s[40:43], s48 offen nt
    s_add_u32 s48, s48, 0x2000
    buffer_load_dwordx4 v[52:55], v4, s[40:43], s48 offen nt
    s_add_u32 s48, s48, 0x2000
    buffer_load_dwordx4 v[56:59], v4, s[40:43], s48 offen nt
    s_add_u32 s48, s48, 0x2000
    buffer_load_dwordx4 v[60:63], v4, s[40:43], s48 offen nt
    s_add_u32 s48, s48, 0x2000
    buffer_load_dwordx4 v[64:67], v4, s[40:43], s48 offen nt
    s_add_u32 s48, s48, 0x2000
    buffer_load_dwordx4 v[68:71], v4, s[40:43], s48 offen nt
    s_add_u32 s48, s48, 0x2000
    buffer_load_dwordx4 v[72:75], v4, s[40:43], s48 offen nt
    s_add_u32 s48, s48, 0x2000
    buffer_load_dwordx4 v[76:79], v4, s[40:43], s48 offen nt
    s_add_u32 s48, s48, 0x2000
    buffer_load_dwordx4 v[80:83], v4, s[40:43], s48 offen nt
    s_add_u32 s48, s48, 0x2000
    buffer_load_dwordx4 v[84:87], v4, s[40:43], s48 offen nt
    s_add_u32 s48, s48, 0x2000
    buffer_load_dwordx4 v[88:91], v4, s[40:43], s48 offen nt
    s_add_u32 s48, s48, 0x2000
    buffer_load_dwordx4 v[92:95], v4, s[40:43], s48 offen nt
    s_add_u32 s48, s48, 0x2000
    buffer_load_dwordx4 v[96:99], v4, s[40:43], s48 offen nt
    s_add_u32 s48, s48, 0x2000
    buffer_load_dwordx4 v[100:103], v4, s[40:43], s48 offen nt
    s_add_u32 s48, s48, 0x2000
    buffer_load_dwordx4 v[104:107], v4, s[40:43], s48 offen nt
    s_add_u32 s48, s48, 0x2000
    buffer_load_dwordx4 v[108:111], v4, s[40:43], s48 offen nt
    s_mov_b32 s36, s24
    s_mov_b32 s37, s25
    buffer_load_dword v17, v6, s[36:39], 0 offen sc1
    s_load_dwordx2 s[20:21], s[0:1], 64
    v_mov_b32 v28, -1
    s_lshl_b32 s48, s2, 8
    s_add_u32 s48, s48, 65536
    v_mov_b32 v29, -1
    v_mov_b32 v30, -1
    v_mov_b32 v31, -1
    s_mov_b32 exec_lo, 0xffff
    s_mov_b32 exec_hi, 0x0
    buffer_store_dwordx4 v[28:31], v5, s[36:39], s48 offen sc1
    s_mov_b64 exec, -1
    v_and_b32 v22, 31, v1
    v_lshlrev_b32 v22, 2, v22
    v_add_u32 v22, 133504, v22
    ds_write_b32 v22, v28
    v_mov_b32 v47, 133568
    s_waitcnt lgkmcnt(0)
    s_barrier
    v_and_b32 v22, 1, v1
    v_lshlrev_b32 v22, 4, v22
    v_mov_b32 v23, 0xffff
    v_lshlrev_b32 v22, v22, v23
    v_bfe_u32 v23, v1, 1, 3
    v_cmp_eq_u32 vcc, 0, v23
    s_nop 1
    v_cndmask_b32 v12, 0, v22, vcc
    v_cmp_eq_u32 vcc, 1, v23
    s_nop 1
    v_cndmask_b32 v13, 0, v22, vcc
    v_cmp_eq_u32 vcc, 2, v23
    s_nop 1
    v_cndmask_b32 v14, 0, v22, vcc
    v_cmp_eq_u32 vcc, 3, v23
    s_nop 1
    v_cndmask_b32 v15, 0, v22, vcc
    s_mov_b32 s48, 0x3f803f80
    s_waitcnt vmcnt(17)
    v_dot2_f32_bf16 v22, v8, s48, 0
    v_dot2_f32_bf16 v23, v8, v8, 0
    v_dot2_f32_bf16 v22, v9, s48, v22
    v_dot2_f32_bf16 v23, v9, v9, v23
    v_dot2_f32_bf16 v22, v10, s48, v22
    v_dot2_f32_bf16 v23, v10, v10, v23
    v_dot2_f32_bf16 v22, v11, s48, v22
    v_dot2_f32_bf16 v23, v11, v11, v23
    s_nop 1
    v_add_f32_dpp v22, v22, v22 quad_perm:[1,0,3,2] row_mask:0xf bank_mask:0xf
    v_add_f32_dpp v23, v23, v23 quad_perm:[1,0,3,2] row_mask:0xf bank_mask:0xf
    s_nop 0
    v_add_f32_dpp v22, v22, v22 quad_perm:[2,3,0,1] row_mask:0xf bank_mask:0xf
    v_add_f32_dpp v23, v23, v23 quad_perm:[2,3,0,1] row_mask:0xf bank_mask:0xf
    s_nop 0
    v_add_f32_dpp v22, v22, v22 row_half_mirror row_mask:0xf bank_mask:0xf
    v_add_f32_dpp v23, v23, v23 row_half_mirror row_mask:0xf bank_mask:0xf
    s_nop 0
    v_add_f32_dpp v22, v22, v22 row_mirror row_mask:0xf bank_mask:0xf
    v_add_f32_dpp v23, v23, v23 row_mirror row_mask:0xf bank_mask:0xf
    s_nop 0
    v_add_f32_dpp v22, v22, v22 row_bcast:15 row_mask:0xa bank_mask:0xf
    v_add_f32_dpp v23, v23, v23 row_bcast:15 row_mask:0xa bank_mask:0xf
    s_nop 0
    v_add_f32_dpp v22, v22, v22 row_bcast:31 row_mask:0xc bank_mask:0xf
    v_add_f32_dpp v23, v23, v23 row_bcast:31 row_mask:0xc bank_mask:0xf
    v_readlane_b32 s56, v22, 63
    v_readlane_b32 s57, v23, 63
    v_mov_b32 v24, 0x3b000000
    v_lshlrev_b32 v16, 16, v16
    v_mul_f32 v22, s56, v24
    v_mul_f32 v23, s57, v24
    v_fma_f32 v23, -v22, v22, v23
    v_max_f32 v23, 0, v23
    v_cvt_pk_bf16_f32 v22, v23, v22
    v_lshlrev_b32 v23, 16, v22
    v_and_b32 v22, 0xffff0000, v22
    v_add_f32 v23, 0x3727c5ac, v23
    v_cvt_pk_bf16_f32 v23, v23, v23
    v_lshlrev_b32 v23, 16, v23
    v_sqrt_f32 v23, v23
    v_sub_f32 v16, v16, v22
    v_cvt_pk_bf16_f32 v23, v23, v23
    v_lshlrev_b32 v23, 16, v23
    v_cvt_pk_bf16_f32 v16, v16, v16
    v_lshlrev_b32 v16, 16, v16
    v_rcp_f32 v23, v23
    s_nop 0
    v_mul_f32 v16, v16, v23
    v_cvt_pk_bf16_f32 v16, v16, v16
    s_nop 1
    v_and_b32_dpp v32, v16, v12 row_newbcast:0 row_mask:0xf bank_mask:0xf
    v_and_b32_dpp v33, v16, v13 row_newbcast:0 row_mask:0xf bank_mask:0xf
    v_and_b32_dpp v34, v16, v14 row_newbcast:0 row_mask:0xf bank_mask:0xf
    v_and_b32_dpp v35, v16, v15 row_newbcast:0 row_mask:0xf bank_mask:0xf
    s_waitcnt vmcnt(16)
    s_nop 0
    v_mfma_f32_16x16x32_bf16 v[20:23], v[48:51], v[32:35], 0
    v_and_b32_dpp v36, v16, v12 row_newbcast:1 row_mask:0xf bank_mask:0xf
    v_and_b32_dpp v37, v16, v13 row_newbcast:1 row_mask:0xf bank_mask:0xf
    v_and_b32_dpp v38, v16, v14 row_newbcast:1 row_mask:0xf bank_mask:0xf
    v_and_b32_dpp v39, v16, v15 row_newbcast:1 row_mask:0xf bank_mask:0xf
    s_waitcnt vmcnt(15)
    s_nop 0
    v_mfma_f32_16x16x32_bf16 v[20:23], v[52:55], v[36:39], v[20:23]
    v_and_b32_dpp v40, v16, v12 row_newbcast:2 row_mask:0xf bank_mask:0xf
    v_and_b32_dpp v41, v16, v13 row_newbcast:2 row_mask:0xf bank_mask:0xf
    v_and_b32_dpp v42, v16, v14 row_newbcast:2 row_mask:0xf bank_mask:0xf
    v_and_b32_dpp v43, v16, v15 row_newbcast:2 row_mask:0xf bank_mask:0xf
    s_waitcnt vmcnt(14)
    s_nop 0
    v_mfma_f32_16x16x32_bf16 v[20:23], v[56:59], v[40:43], v[20:23]
    v_and_b32_dpp v32, v16, v12 row_newbcast:3 row_mask:0xf bank_mask:0xf
    v_and_b32_dpp v33, v16, v13 row_newbcast:3 row_mask:0xf bank_mask:0xf
    v_and_b32_dpp v34, v16, v14 row_newbcast:3 row_mask:0xf bank_mask:0xf
    v_and_b32_dpp v35, v16, v15 row_newbcast:3 row_mask:0xf bank_mask:0xf
    s_waitcnt vmcnt(13)
    s_nop 0
    v_mfma_f32_16x16x32_bf16 v[20:23], v[60:63], v[32:35], v[20:23]
    v_and_b32_dpp v36, v16, v12 row_newbcast:4 row_mask:0xf bank_mask:0xf
    v_and_b32_dpp v37, v16, v13 row_newbcast:4 row_mask:0xf bank_mask:0xf
    v_and_b32_dpp v38, v16, v14 row_newbcast:4 row_mask:0xf bank_mask:0xf
    v_and_b32_dpp v39, v16, v15 row_newbcast:4 row_mask:0xf bank_mask:0xf
    s_waitcnt vmcnt(12)
    s_nop 0
    v_mfma_f32_16x16x32_bf16 v[20:23], v[64:67], v[36:39], v[20:23]
    v_and_b32_dpp v40, v16, v12 row_newbcast:5 row_mask:0xf bank_mask:0xf
    v_and_b32_dpp v41, v16, v13 row_newbcast:5 row_mask:0xf bank_mask:0xf
    v_and_b32_dpp v42, v16, v14 row_newbcast:5 row_mask:0xf bank_mask:0xf
    v_and_b32_dpp v43, v16, v15 row_newbcast:5 row_mask:0xf bank_mask:0xf
    s_waitcnt vmcnt(11)
    s_nop 0
    v_mfma_f32_16x16x32_bf16 v[20:23], v[68:71], v[40:43], v[20:23]
    v_and_b32_dpp v32, v16, v12 row_newbcast:6 row_mask:0xf bank_mask:0xf
    v_and_b32_dpp v33, v16, v13 row_newbcast:6 row_mask:0xf bank_mask:0xf
    v_and_b32_dpp v34, v16, v14 row_newbcast:6 row_mask:0xf bank_mask:0xf
    v_and_b32_dpp v35, v16, v15 row_newbcast:6 row_mask:0xf bank_mask:0xf
    s_waitcnt vmcnt(10)
    s_nop 0
    v_mfma_f32_16x16x32_bf16 v[20:23], v[72:75], v[32:35], v[20:23]
    v_and_b32_dpp v36, v16, v12 row_newbcast:7 row_mask:0xf bank_mask:0xf
    v_and_b32_dpp v37, v16, v13 row_newbcast:7 row_mask:0xf bank_mask:0xf
    v_and_b32_dpp v38, v16, v14 row_newbcast:7 row_mask:0xf bank_mask:0xf
    v_and_b32_dpp v39, v16, v15 row_newbcast:7 row_mask:0xf bank_mask:0xf
    s_waitcnt vmcnt(9)
    s_nop 0
    v_mfma_f32_16x16x32_bf16 v[20:23], v[76:79], v[36:39], v[20:23]
    v_and_b32_dpp v40, v16, v12 row_newbcast:8 row_mask:0xf bank_mask:0xf
    v_and_b32_dpp v41, v16, v13 row_newbcast:8 row_mask:0xf bank_mask:0xf
    v_and_b32_dpp v42, v16, v14 row_newbcast:8 row_mask:0xf bank_mask:0xf
    v_and_b32_dpp v43, v16, v15 row_newbcast:8 row_mask:0xf bank_mask:0xf
    s_waitcnt vmcnt(8)
    s_nop 0
    v_mfma_f32_16x16x32_bf16 v[20:23], v[80:83], v[40:43], v[20:23]
    v_and_b32_dpp v32, v16, v12 row_newbcast:9 row_mask:0xf bank_mask:0xf
    v_and_b32_dpp v33, v16, v13 row_newbcast:9 row_mask:0xf bank_mask:0xf
    v_and_b32_dpp v34, v16, v14 row_newbcast:9 row_mask:0xf bank_mask:0xf
    v_and_b32_dpp v35, v16, v15 row_newbcast:9 row_mask:0xf bank_mask:0xf
    s_waitcnt vmcnt(7)
    s_nop 0
    v_mfma_f32_16x16x32_bf16 v[20:23], v[84:87], v[32:35], v[20:23]
    v_and_b32_dpp v36, v16, v12 row_newbcast:10 row_mask:0xf bank_mask:0xf
    v_and_b32_dpp v37, v16, v13 row_newbcast:10 row_mask:0xf bank_mask:0xf
    v_and_b32_dpp v38, v16, v14 row_newbcast:10 row_mask:0xf bank_mask:0xf
    v_and_b32_dpp v39, v16, v15 row_newbcast:10 row_mask:0xf bank_mask:0xf
    s_waitcnt vmcnt(6)
    s_nop 0
    v_mfma_f32_16x16x32_bf16 v[20:23], v[88:91], v[36:39], v[20:23]
    v_and_b32_dpp v40, v16, v12 row_newbcast:11 row_mask:0xf bank_mask:0xf
    v_and_b32_dpp v41, v16, v13 row_newbcast:11 row_mask:0xf bank_mask:0xf
    v_and_b32_dpp v42, v16, v14 row_newbcast:11 row_mask:0xf bank_mask:0xf
    v_and_b32_dpp v43, v16, v15 row_newbcast:11 row_mask:0xf bank_mask:0xf
    s_waitcnt vmcnt(5)
    s_nop 0
    v_mfma_f32_16x16x32_bf16 v[20:23], v[92:95], v[40:43], v[20:23]
    v_and_b32_dpp v32, v16, v12 row_newbcast:12 row_mask:0xf bank_mask:0xf
    v_and_b32_dpp v33, v16, v13 row_newbcast:12 row_mask:0xf bank_mask:0xf
    v_and_b32_dpp v34, v16, v14 row_newbcast:12 row_mask:0xf bank_mask:0xf
    v_and_b32_dpp v35, v16, v15 row_newbcast:12 row_mask:0xf bank_mask:0xf
    s_waitcnt vmcnt(4)
    s_nop 0
    v_mfma_f32_16x16x32_bf16 v[20:23], v[96:99], v[32:35], v[20:23]
    v_and_b32_dpp v36, v16, v12 row_newbcast:13 row_mask:0xf bank_mask:0xf
    v_and_b32_dpp v37, v16, v13 row_newbcast:13 row_mask:0xf bank_mask:0xf
    v_and_b32_dpp v38, v16, v14 row_newbcast:13 row_mask:0xf bank_mask:0xf
    v_and_b32_dpp v39, v16, v15 row_newbcast:13 row_mask:0xf bank_mask:0xf
    s_waitcnt vmcnt(3)
    s_nop 0
    v_mfma_f32_16x16x32_bf16 v[20:23], v[100:103], v[36:39], v[20:23]
    v_and_b32_dpp v40, v16, v12 row_newbcast:14 row_mask:0xf bank_mask:0xf
    v_and_b32_dpp v41, v16, v13 row_newbcast:14 row_mask:0xf bank_mask:0xf
    v_and_b32_dpp v42, v16, v14 row_newbcast:14 row_mask:0xf bank_mask:0xf
    v_and_b32_dpp v43, v16, v15 row_newbcast:14 row_mask:0xf bank_mask:0xf
    s_waitcnt vmcnt(2)
    s_nop 0
    v_mfma_f32_16x16x32_bf16 v[20:23], v[104:107], v[40:43], v[20:23]
    v_and_b32_dpp v32, v16, v12 row_newbcast:15 row_mask:0xf bank_mask:0xf
    v_and_b32_dpp v33, v16, v13 row_newbcast:15 row_mask:0xf bank_mask:0xf
    v_and_b32_dpp v34, v16, v14 row_newbcast:15 row_mask:0xf bank_mask:0xf
    v_and_b32_dpp v35, v16, v15 row_newbcast:15 row_mask:0xf bank_mask:0xf
    s_waitcnt vmcnt(1)
    s_nop 0
    v_mfma_f32_16x16x32_bf16 v[20:23], v[108:111], v[32:35], v[20:23]
    v_lshlrev_b32 v18, 7, v2
    v_lshl_add_u32 v18, v3, 4, v18
    s_lshl_b32 s48, s2, 9
    s_add_u32 s48, s48, 131072
    s_lshl_b32 s49, s26, 12
    s_add_u32 s49, s49, 131072
    s_waitcnt vmcnt(0)
    v_add_u32 v17, 1, v17
    v_and_b32 v15, 0xff, v17
    v_bfi_b32 v20, s63, v17, v20
    v_bfi_b32 v21, s63, v17, v21
    v_bfi_b32 v22, s63, v17, v22
    v_bfi_b32 v23, s63, v17, v23
    s_mov_b32 exec_lo, 0xff00ff
    s_mov_b32 exec_hi, 0xff00ff
    buffer_store_dwordx4 v[20:23], v18, s[36:39], s48 offen sc1
    s_getreg_b32 s55, hwreg(HW_REG_XCC_ID, 0, 4)
    s_cmp_lg_u32 s60, 2
    s_cbranch_scc1 L_noxc
    s_mov_b64 exec, 1
    v_mov_b32 v16, s55
    s_lshl_b32 s48, s26, 3
    s_add_u32 s48, s48, 16384
    buffer_store_dwordx2 v[16:17], v6, s[36:39], s48 offen sc1
L_noxc:
    s_mov_b64 exec, -1
    v_bfe_u32 v19, v1, 3, 2
    v_lshlrev_b32 v19, 6, v19
    v_lshrrev_b32 v24, 5, v1
    v_lshl_add_u32 v19, v24, 4, v19
    v_and_b32 v24, 7, v1
    v_lshl_add_u32 v19, v24, 1, v19
    v_add_u32 v19, 133120, v19
    s_waitcnt vmcnt(0)
L_qdel:
    s_sub_u32 s62, s62, 1
    s_cmp_lt_i32 s62, 0
    s_cbranch_scc1 L_qdelgo
    ds_read_b32 v24, v47 offset:4
    s_waitcnt lgkmcnt(0)
    v_cmp_eq_u32 vcc, -1, v24
    s_cbranch_vccnz L_qdel
L_qdelgo:
L_qpoll:
    s_sub_u32 s62, s62, 1
    s_cmp_lt_i32 s62, 0
    s_cbranch_scc1 L_qpollok0
    buffer_load_dwordx4 v[48:51], v5, s[36:39], s49 offen offset:0 sc1
    buffer_load_dwordx4 v[52:55], v5, s[36:39], s49 offen offset:1024 sc1
    buffer_load_dwordx4 v[56:59], v5, s[36:39], s49 offen offset:2048 sc1
    buffer_load_dwordx4 v[60:63], v5, s[36:39], s49 offen offset:3072 sc1
    s_waitcnt vmcnt(0)
    v_xor_b32 v48, v48, v15
    v_xor_b32 v49, v49, v15
    v_xor_b32 v50, v50, v15
    v_xor_b32 v51, v51, v15
    v_xor_b32 v52, v52, v15
    v_xor_b32 v53, v53, v15
    v_xor_b32 v54, v54, v15
    v_xor_b32 v55, v55, v15
    v_xor_b32 v56, v56, v15
    v_xor_b32 v57, v57, v15
    v_xor_b32 v58, v58, v15
    v_xor_b32 v59, v59, v15
    v_xor_b32 v60, v60, v15
    v_xor_b32 v61, v61, v15
    v_xor_b32 v62, v62, v15
    v_xor_b32 v63, v63, v15
    v_or3_b32 v24, v48, v49, v50
    v_or3_b32 v25, v51, v52, v53
    v_or3_b32 v26, v54, v55, v56
    v_or3_b32 v27, v57, v58, v59
    v_or3_b32 v28, v60, v61, v62
    v_or3_b32 v29, v24, v25, v26
    v_or3_b32 v30, v27, v28, v63
    v_bitop3_b32 v24, v29, v30, s63 bitop3:0xa8
    v_cmp_ne_u32 vcc, 0, v24
    s_cbranch_vccnz L_qpoll
L_qpollok0:
    v_add_f32 v32, v48, v52
    v_add_f32 v40, v56, v60
    v_add_f32 v33, v49, v53
    v_add_f32 v41, v57, v61
    v_add_f32 v34, v50, v54
    v_add_f32 v42, v58, v62
    v_add_f32 v35, v51, v55
    v_add_f32 v43, v59, v63
L_qpolldone:
    v_add_f32 v32, v32, v40
    v_add_f32 v33, v33, v41
    v_add_f32 v34, v34, v42
    v_add_f32 v35, v35, v43
    v_permlane32_swap_b32 v32, v33
    s_nop 0
    v_permlane32_swap_b32 v34, v35
    v_add_f32 v32, v32, v33
    v_add_f32 v34, v34, v35
    v_cvt_pk_bf16_f32 v32, v32, v34
    ds_write_b16 v19, v32
    ds_write_b16_d16_hi v19, v32 offset:32
    ds_write_b32 v47, v15 offset:48
    s_waitcnt lgkmcnt(0)
L_qskip:
    s_cmp_lg_u32 s60, 1
    s_cbranch_scc1 L_tagpollgo
    s_lshr_b32 s48, s26, 3
    s_lshl_b32 s48, s48, 15
    s_add_u32 s48, s48, 131072
    v_lshlrev_b32 v22, 9, v1
L_tagpoll:
    s_sub_u32 s62, s62, 1
    s_cmp_lt_i32 s62, 0
    s_cbranch_scc1 L_tagpollgo
    buffer_load_dwordx4 v[32:35], v22, s[36:39], s48 offen sc1
    s_waitcnt vmcnt(0)
    v_xor_b32 v32, v32, v15
    v_xor_b32 v33, v33, v15
    v_xor_b32 v34, v34, v15
    v_xor_b32 v35, v35, v15
    v_or3_b32 v24, v32, v33, v34
    v_bitop3_b32 v24, v24, v35, s63 bitop3:0xa8
    v_cmp_ne_u32 vcc, 0, v24
    s_cbranch_vccnz L_tagpoll
    v_mov_b32 v11, v17
    v_lshlrev_b32 v27, 2, v1
    v_add_u32 v27, 135168, v27
    s_branch L_s2pollgo
L_s2back:
    v_mov_b32 v17, v11
    v_mov_b32 v47, 133568
L_tagpollgo:
    v_and_b32 v45, 7, v1
    v_lshlrev_b32 v44, 9, v45
    v_lshlrev_b32 v45, 4, v45
L_ca0:
    s_sub_u32 s62, s62, 1
    s_cmp_lt_i32 s62, 0
    s_cbranch_scc1 L_ca0go
    ds_read_b32 v23, v47 offset:16
    s_waitcnt lgkmcnt(0)
    v_cmp_gt_i32 vcc, 55, v23
    s_cbranch_vccnz L_ca0
L_ca0go:
    s_mul_i32 s49, s26, 4352
    s_add_u32 s49, s49, 1048576
    s_lshl_b32 s50, s27, 9
    s_add_u32 s50, s49, s50
    v_mov_b32 v40, v17
    v_mov_b32 v41, v17
    v_mov_b32 v42, v17
    v_mov_b32 v43, v17
    s_mov_b32 exec_lo, 0xff
    s_mov_b32 exec_hi, 0x0
    buffer_store_dwordx4 v[40:43], v5, s[36:39], s50 offen sc1
    s_mov_b64 exec, -1
L_cb0:
    s_sub_u32 s62, s62, 1
    s_cmp_lt_i32 s62, 0
    s_cbranch_scc1 L_cb0go
    ds_read_b32 v23, v47 offset:16
    s_waitcnt lgkmcnt(0)
    v_cmp_gt_i32 vcc, 67, v23
    s_cbranch_vccnz L_cb0
L_cb0go:
    s_waitcnt vmcnt(0)
    v_mov_b32 v41, -1
    s_mov_b32 exec_lo, 0xff
    s_mov_b32 exec_hi, 0x0
L_ct0:
    s_sub_u32 s62, s62, 1
    s_cmp_lt_i32 s62, 0
    s_cbranch_scc1 L_ct0go
    buffer_load_dwordx2 v[42:43], v44, s[36:39], s49 offen sc1
    s_waitcnt vmcnt(0)
    v_cmp_ne_u32 vcc, v43, v17
    s_bcnt1_i32_b64 s50, vcc
    s_cmp_lt_u32 s50, 2
    s_cbranch_scc1 L_ct0go
    s_mov_b64 exec, vcc
    ds_write_b32 v47, v6 offset:12
    s_branch L_ct0
L_ct0go:
    s_mov_b64 exec, -1
    ds_write_b32 v47, v41 offset:12
    v_lshrrev_b32 v22, 3, v3
    v_lshlrev_b32 v46, 5, v22
    v_add_u32 v46, 133504, v46
L_mlpoll:
    s_sub_u32 s62, s62, 1
    s_cmp_lt_i32 s62, 0
    s_cbranch_scc1 L_mlpollgo
    ds_read_b128 v[24:27], v46
    ds_read_b128 v[28:31], v46 offset:16
    s_waitcnt lgkmcnt(0)
    v_max3_u32 v40, v24, v25, v26
    v_max3_u32 v41, v27, v28, v29
    v_max3_u32 v40, v40, v30, v31
    v_max_u32 v40, v40, v41
    v_cmp_eq_u32 vcc, -1, v40
    s_cbranch_vccnz L_mlpoll
L_mlpollgo:
    v_max3_f32 v32, v24, v26, v28
    v_max_f32 v32, v32, v30
    s_nop 1
    v_max_f32_dpp v32, v32, v32 row_ror:8 row_mask:0xf bank_mask:0xf
    v_sub_f32 v40, v24, v32
    v_sub_f32 v41, v26, v32
    v_sub_f32 v42, v28, v32
    v_sub_f32 v43, v30, v32
    v_exp_f32 v40, v40
    v_exp_f32 v41, v41
    v_exp_f32 v42, v42
    v_exp_f32 v43, v43
    v_mul_f32 v34, v40, v25
    v_fmac_f32 v34, v41, v27
    v_fmac_f32 v34, v42, v29
    v_fmac_f32 v34, v43, v31
    s_nop 1
    v_add_f32_dpp v34, v34, v34 row_ror:8 row_mask:0xf bank_mask:0xf
    v_mov_b32 v33, v17
    v_mov_b32 v35, v17
    s_mul_i32 s49, s26, 4352
    s_add_u32 s49, s49, 393216
    s_lshl_b32 s50, s27, 9
    s_add_u32 s50, s49, s50
    s_mov_b32 exec_lo, 0xff
    s_mov_b32 exec_hi, 0x0
    buffer_store_dwordx4 v[32:35], v5, s[36:39], s50 offen sc1
    s_mov_b64 exec, -1
    v_and_b32 v45, 7, v1
    v_lshlrev_b32 v44, 9, v45
    v_lshlrev_b32 v45, 4, v45
L_fpoll:
    s_sub_u32 s62, s62, 1
    s_cmp_lt_i32 s62, 0
    s_cbranch_scc1 L_fpollgo
    ds_read_b32 v23, v47
    s_waitcnt lgkmcnt(0)
    v_cmp_eq_u32 vcc, -1, v23
    s_cbranch_vccnz L_fpoll
L_fpollgo:
    s_waitcnt vmcnt(0)
    v_mov_b32 v41, -1
    s_mov_b32 exec_lo, 0xff
    s_mov_b32 exec_hi, 0x0
L_tpoll:
    s_sub_u32 s62, s62, 1
    s_cmp_lt_i32 s62, 0
    s_cbranch_scc1 L_tpollgo
    buffer_load_dwordx2 v[42:43], v44, s[36:39], s49 offen sc1
    s_waitcnt vmcnt(0)
    v_cmp_ne_u32 vcc, v43, v17
    s_bcnt1_i32_b64 s50, vcc
    s_cmp_lt_u32 s50, 2
    s_cbranch_scc1 L_tpollgo
    s_mov_b64 exec, vcc
    ds_write_b32 v47, v6 offset:12
    s_branch L_tpoll
L_tpollgo:
    s_mov_b64 exec, -1
    ds_write_b32 v47, v41 offset:12
    s_cmp_lg_u32 s60, 2
    s_cbranch_scc1 L_hpoll
    v_min_u32 v40, 27, v1
    v_lshlrev_b32 v40, 3, v40
    s_movk_i32 s50, 16384
L_xpoll:
    s_sub_u32 s62, s62, 1
    s_cmp_lt_i32 s62, 0
    s_cbranch_scc1 L_xpollgo
    buffer_load_dwordx2 v[36:37], v40, s[36:39], s50 offen sc1
    s_waitcnt vmcnt(0)
    v_cmp_ne_u32 vcc, v37, v17
    s_cbranch_vccnz L_xpoll
L_xpollgo:
    v_cmp_ne_u32 vcc, s55, v36
    s_cmp_eq_u64 vcc, 0
    s_cselect_b32 s50, 1, 0
    v_mov_b32 v36, s50
    ds_write_b32 v47, v36 offset:52
L_hpoll:
    s_sub_u32 s62, s62, 1
    s_cmp_lt_i32 s62, 0
    s_cbranch_scc1 L_hpollgo
    buffer_load_dwordx4 v[36:39], v44, s[36:39], s49 offen sc1
    s_waitcnt vmcnt(0)
    v_bitop3_b32 v40, v37, v39, v17 bitop3:0x7e
    v_cmp_ne_u32 vcc, 0, v40
    s_cbranch_vccnz L_hpoll
L_hpollgo:
    v_mov_b32 v20, v36
    s_nop 1
    v_max_f32_dpp v20, v20, v20 quad_perm:[1,0,3,2] row_mask:0xf bank_mask:0xf
    s_nop 1
    v_max_f32_dpp v20, v20, v20 quad_perm:[2,3,0,1] row_mask:0xf bank_mask:0xf
    s_nop 1
    v_max_f32_dpp v20, v20, v20 row_half_mirror row_mask:0xf bank_mask:0xf
    v_sub_f32 v36, v36, v20
    v_exp_f32 v36, v36
    s_nop 0
    v_mul_f32 v21, v36, v38
    s_nop 1
    v_add_f32_dpp v21, v21, v21 quad_perm:[1,0,3,2] row_mask:0xf bank_mask:0xf
    s_nop 1
    v_add_f32_dpp v21, v21, v21 quad_perm:[2,3,0,1] row_mask:0xf bank_mask:0xf
    s_nop 1
    v_add_f32_dpp v21, v21, v21 row_half_mirror row_mask:0xf bank_mask:0xf
    v_rcp_f32 v21, v21
    v_sub_f32 v24, v24, v20
    v_sub_f32 v25, v26, v20
    v_sub_f32 v26, v28, v20
    v_sub_f32 v27, v30, v20
    v_exp_f32 v24, v24
    v_exp_f32 v25, v25
    v_exp_f32 v26, v26
    v_exp_f32 v27, v27
    v_mul_f32 v24, v24, v21
    v_mul_f32 v25, v25, v21
    v_mul_f32 v26, v26, v21
    v_mul_f32 v27, v27, v21
    v_lshlrev_b32 v18, 12, v22
    v_lshl_add_u32 v18, v2, 8, v18
    v_add_u32 v18, v18, v45
    v_add_u32 v18, 137728, v18
    v_lshlrev_b32 v19, 6, v2
    v_lshrrev_b32 v23, 1, v45
    v_add_u32 v19, v19, v23
    s_lshl_b32 s48, s2, 8
    s_add_u32 s48, s48, 65536
    v_mov_b32 v13, v19
    v_mov_b32 v19, 0x7ff00000
    s_mov_b32 s54, 1
    s_branch L_s1body
L_s1real:
    v_mov_b32 v19, v13
    s_mov_b32 s54, 0
    s_waitcnt vmcnt(0) lgkmcnt(0)
    s_barrier
L_s1body:
    ds_read_b128 v[32:35], v18 offset:0
    ds_read_b128 v[36:39], v18 offset:1024
    ds_read_b128 v[40:43], v18 offset:2048
    ds_read_b128 v[44:47], v18 offset:3072
    s_waitcnt lgkmcnt(3)
    v_mul_f32 v32, v32, v24
    v_mul_f32 v33, v33, v24
    v_mul_f32 v34, v34, v24
    v_mul_f32 v35, v35, v24
    s_waitcnt lgkmcnt(2)
    v_fmac_f32 v32, v36, v25
    v_fmac_f32 v33, v37, v25
    v_fmac_f32 v34, v38, v25
    v_fmac_f32 v35, v39, v25
    s_waitcnt lgkmcnt(1)
    v_fmac_f32 v32, v40, v26
    v_fmac_f32 v33, v41, v26
    v_fmac_f32 v34, v42, v26
    v_fmac_f32 v35, v43, v26
    s_waitcnt lgkmcnt(0)
    v_fmac_f32 v32, v44, v27
    v_fmac_f32 v33, v45, v27
    v_fmac_f32 v34, v46, v27
    v_fmac_f32 v35, v47, v27
    v_add_f32_dpp v32, v32, v32 row_ror:8 row_mask:0xf bank_mask:0xf
    v_add_f32_dpp v33, v33, v33 row_ror:8 row_mask:0xf bank_mask:0xf
    v_add_f32_dpp v34, v34, v34 row_ror:8 row_mask:0xf bank_mask:0xf
    v_add_f32_dpp v35, v35, v35 row_ror:8 row_mask:0xf bank_mask:0xf
    v_cvt_pk_bf16_f32 v32, v32, v33
    v_cvt_pk_bf16_f32 v33, v34, v35
    v_min_u32 v32, -2, v32
    v_min_u32 v33, -2, v33
    s_nop 0
    v_mov_b32_dpp v34, v32 quad_perm:[1,0,3,2] row_mask:0xf bank_mask:0xf
    v_mov_b32_dpp v35, v33 quad_perm:[1,0,3,2] row_mask:0xf bank_mask:0xf
    s_mov_b32 exec_lo, 0x550055
    s_mov_b32 exec_hi, 0x550055
    buffer_store_dwordx4 v[32:35], v19, s[36:39], s48 offen sc1
    s_mov_b64 exec, -1
    s_cmp_lg_u32 s54, 0
    s_cbranch_scc1 L_s1real
    s_cmp_eq_u32 s60, 0
    s_cbranch_scc1 L_svend
    s_cmp_eq_u32 s60, 2
    s_cbranch_scc1 L_svffn
    v_lshlrev_b32 v18, 9, v2
    v_lshl_add_u32 v18, v3, 4, v18
    v_add_u32 v18, 135168, v18
    v_and_b32 v19, 1, v2
    v_lshlrev_b32 v19, 1, v19
    v_lshrrev_b32 v22, 1, v2
    v_or_b32 v19, v19, v22
    v_lshl_add_u32 v19, v3, 2, v19
    v_lshlrev_b32 v19, 2, v19
    s_lshl_b32 s48, s26, 8
    s_add_u32 s48, s48, 262144
    s_add_u32 s49, s48, 0x2000
    s_barrier
L_yfbody:
    ds_read_b128 v[24:27], v18
    ds_read_b128 v[28:31], v18 offset:256
    s_waitcnt lgkmcnt(0)
    v_add_f32 v24, v24, v28
    v_add_f32 v25, v25, v29
    v_add_f32 v26, v26, v30
    v_add_f32 v27, v27, v31
    v_permlane32_swap_b32 v24, v25
    s_nop 0
    v_permlane32_swap_b32 v26, v27
    v_add_f32 v24, v24, v25
    v_add_f32 v26, v26, v27
    s_nop 1
    v_permlane16_swap_b32 v24, v26
    v_add_f32 v24, v24, v26
    v_bfi_b32 v24, s63, v17, v24
    buffer_store_dword v24, v19, s[36:39], s48 offen sc1
    s_branch L_svend
L_svffn:
    s_mov_b32 s44, s20
    s_mov_b32 s45, s21
    s_mov_b32 s46, 1024
    s_mov_b32 s47, 0x20000
    v_and_b32 v22, 1, v2
    v_lshlrev_b32 v22, 1, v22
    v_lshrrev_b32 v23, 1, v2
    v_or_b32 v22, v22, v23
    v_and_b32 v23, 7, v1
    v_lshl_add_u32 v22, v23, 2, v22
    s_lshl_b32 s48, s26, 5
    v_add_u32 v22, s48, v22
    v_and_b32 v22, 0x1ff, v22
    v_lshlrev_b32 v19, 1, v22
    v_add_u32 v18, 133632, v19
    v_lshrrev_b32 v24, 3, v1
    v_lshlrev_b32 v24, 11, v24
    v_lshl_add_u32 v20, v23, 4, v24
    s_and_b32 s48, s26, 15
    s_lshl_b32 s48, s48, 7
    s_add_u32 s48, s48, 278528
    s_add_u32 s49, s48, 0x4000
    s_add_u32 s50, s48, 0x8000
    s_add_u32 s51, s48, 0xc000
    v_mov_b32 v14, 0
    s_mov_b32 exec_hi, 0
    v_mov_b32 v14, v15
    s_mov_b32 exec_hi, -1
    v_mov_b32 v60, 0
    v_mov_b32 v61, 0
    v_mov_b32 v62, 0
    v_mov_b32 v63, 0
    v_mov_b32 v76, 0
    v_mov_b32 v77, 0
    v_mov_b32 v78, 0
    v_mov_b32 v79, 0
    v_mov_b32 v13, v19
    v_mov_b32 v19, 0x7ff00000
    s_mov_b32 s54, 1
    s_branch L_s4pollok1
L_s4real:
    v_mov_b32 v19, v13
    s_mov_b32 s54, 0
    buffer_load_dwordx4 v[112:115], v20, s[36:39], s48 offen sc1
    buffer_load_dwordx4 v[116:119], v20, s[36:39], s49 offen sc1
    buffer_load_dwordx4 v[120:123], v20, s[36:39], s50 offen sc1
    s_mov_b32 exec_hi, 0
    buffer_load_dwordx4 v[124:127], v20, s[36:39], s51 offen sc1
    s_mov_b32 exec_hi, -1
    s_barrier
    v_lshlrev_b32 v23, 7, v1
    s_mov_b32 s52, 262144
    s_mov_b32 s53, 4194304
L_gpoll:
    s_sub_u32 s53, s53, 1
    s_cbranch_scc1 L_gpollgo
    buffer_load_dwordx4 v[32:35], v23, s[36:39], s52 offen sc1
    s_waitcnt vmcnt(0)
    v_xor_b32 v32, v32, v15
    v_xor_b32 v33, v33, v15
    v_xor_b32 v34, v34, v15
    v_xor_b32 v35, v35, v15
    v_or3_b32 v24, v32, v33, v34
    v_bitop3_b32 v24, v24, v35, s63 bitop3:0xa8
    v_cmp_ne_u32 vcc, 0, v24
    s_cmp_eq_u64 vcc, exec
    s_cbranch_scc1 L_gpoll
L_gpollgo:
    s_barrier
    s_barrier
    ds_read_u16 v21, v18
    s_cmp_eq_u32 s26, 27
    s_cbranch_scc1 L_epoch
    s_cmp_ge_u32 s26, 16
    s_cbranch_scc1 L_svend
    buffer_load_dwordx4 v[48:51], v20, s[36:39], s48 offen sc1
    buffer_load_dwordx4 v[52:55], v20, s[36:39], s49 offen sc1
    buffer_load_dwordx4 v[56:59], v20, s[36:39], s50 offen sc1
    s_mov_b32 exec_hi, 0
    buffer_load_dwordx4 v[60:63], v20, s[36:39], s51 offen sc1
    s_mov_b32 exec_hi, -1
L_s4poll:
    s_sub_u32 s62, s62, 1
    s_cmp_lt_i32 s62, 0
    s_cbranch_scc1 L_s4pollok0
    buffer_load_dwordx4 v[64:67], v20, s[36:39], s48 offen sc1
    buffer_load_dwordx4 v[68:71], v20, s[36:39], s49 offen sc1
    buffer_load_dwordx4 v[72:75], v20, s[36:39], s50 offen sc1
    s_mov_b32 exec_hi, 0
    buffer_load_dwordx4 v[76:79], v20, s[36:39], s51 offen sc1
    s_mov_b32 exec_hi, -1
    s_waitcnt vmcnt(4)
    v_xor_b32 v48, v48, v15
    v_xor_b32 v49, v49, v15
    v_xor_b32 v50, v50, v15
    v_xor_b32 v51, v51, v15
    v_xor_b32 v52, v52, v15
    v_xor_b32 v53, v53, v15
    v_xor_b32 v54, v54, v15
    v_xor_b32 v55, v55, v15
    v_xor_b32 v56, v56, v15
    v_xor_b32 v57, v57, v15
    v_xor_b32 v58, v58, v15
    v_xor_b32 v59, v59, v15
    v_xor_b32 v60, v60, v14
    v_xor_b32 v61, v61, v14
    v_xor_b32 v62, v62, v14
    v_xor_b32 v63, v63, v14
    v_or3_b32 v24, v48, v49, v50
    v_or3_b32 v25, v51, v52, v53
    v_or3_b32 v26, v54, v55, v56
    v_or3_b32 v27, v57, v58, v59
    v_or3_b32 v28, v60, v61, v62
    v_or3_b32 v29, v24, v25, v26
    v_or3_b32 v30, v27, v28, v63
    v_bitop3_b32 v24, v29, v30, s63 bitop3:0xa8
    v_cmp_ne_u32 vcc, 0, v24
    s_cbranch_vccz L_s4pollok0
    buffer_load_dwordx4 v[48:51], v20, s[36:39], s48 offen sc1
    buffer_load_dwordx4 v[52:55], v20, s[36:39], s49 offen sc1
    buffer_load_dwordx4 v[56:59], v20, s[36:39], s50 offen sc1
    s_mov_b32 exec_hi, 0
    buffer_load_dwordx4 v[60:63], v20, s[36:39], s51 offen sc1
    s_mov_b32 exec_hi, -1
    s_waitcnt vmcnt(4)
    v_xor_b32 v64, v64, v15
    v_xor_b32 v65, v65, v15
    v_xor_b32 v66, v66, v15
    v_xor_b32 v67, v67, v15
    v_xor_b32 v68, v68, v15
    v_xor_b32 v69, v69, v15
    v_xor_b32 v70, v70, v15
    v_xor_b32 v71, v71, v15
    v_xor_b32 v72, v72, v15
    v_xor_b32 v73, v73, v15
    v_xor_b32 v74, v74, v15
    v_xor_b32 v75, v75, v15
    v_xor_b32 v76, v76, v14
    v_xor_b32 v77, v77, v14
    v_xor_b32 v78, v78, v14
    v_xor_b32 v79, v79, v14
    v_or3_b32 v24, v64, v65, v66
    v_or3_b32 v25, v67, v68, v69
    v_or3_b32 v26, v70, v71, v72
    v_or3_b32 v27, v73, v74, v75
    v_or3_b32 v28, v76, v77, v78
    v_or3_b32 v29, v24, v25, v26
    v_or3_b32 v30, v27, v28, v79
    v_bitop3_b32 v24, v29, v30, s63 bitop3:0xa8
    v_cmp_ne_u32 vcc, 0, v24
    s_cbranch_vccnz L_s4poll
L_s4pollok1:
    v_add_f32 v32, v64, v68
    v_add_f32 v40, v72, v76
    v_add_f32 v33, v65, v69
    v_add_f32 v41, v73, v77
    v_add_f32 v34, v66, v70
    v_add_f32 v42, v74, v78
    v_add_f32 v35, v67, v71
    v_add_f32 v43, v75, v79
    s_branch L_s4polldone
L_s4pollok0:
    v_add_f32 v32, v48, v52
    v_add_f32 v40, v56, v60
    v_add_f32 v33, v49, v53
    v_add_f32 v41, v57, v61
    v_add_f32 v34, v50, v54
    v_add_f32 v42, v58, v62
    v_add_f32 v35, v51, v55
    v_add_f32 v43, v59, v63
L_s4polldone:
    v_add_f32 v32, v32, v40
    v_add_f32 v33, v33, v41
    v_add_f32 v34, v34, v42
    v_add_f32 v35, v35, v43
    s_waitcnt lgkmcnt(0)
    v_lshlrev_b32 v21, 16, v21
    v_permlane32_swap_b32 v32, v33
    v_permlane32_swap_b32 v34, v35
    v_add_f32 v32, v32, v33
    v_add_f32 v34, v34, v35
    s_nop 1
    v_permlane16_swap_b32 v32, v34
    v_add_f32 v32, v32, v34
    s_nop 1
    v_add_f32_dpp v32, v32, v32 row_ror:8 row_mask:0xf bank_mask:0xf
    v_cvt_pk_bf16_f32 v32, v32, v32
    v_lshlrev_b32 v32, 16, v32
    v_add_f32 v32, v32, v21
    v_cvt_pk_bf16_f32 v32, v32, v32
    s_mov_b32 exec_lo, 0xff00ff
    s_mov_b32 exec_hi, 0xff00ff
    buffer_store_short v32, v19, s[44:47], 0 offen
    s_mov_b64 exec, -1
    s_cmp_lg_u32 s54, 0
    s_cbranch_scc1 L_s4real
    s_branch L_svend
L_epoch:
    s_mov_b64 exec, 1
    buffer_store_dword v17, v6, s[36:39], 0 offen sc1
L_svend:
L_end:
    s_endpgm
.section .rodata,"a"
.p2align 6
.amdhsa_kernel sequential_preLN__mha_block_cached__dense_activation_silu__decode_kernel
  .amdhsa_next_free_vgpr 168
  .amdhsa_next_free_sgpr 96
  .amdhsa_accum_offset 168
  .amdhsa_group_segment_fixed_size 0
  .amdhsa_kernarg_size 88
  .amdhsa_user_sgpr_count 2
  .amdhsa_user_sgpr_kernarg_segment_ptr 1
  .amdhsa_system_sgpr_workgroup_id_x 1
.end_amdhsa_kernel
```
